```python
import torch

def _softmax(x, axis=-1):
    return torch.softmax(x, dim=axis)
def _gelu(x):
    return torch.nn.functional.gelu(x, approximate="tanh")
def _silu(x):
    return torch.nn.functional.silu(x)
def _sigmoid(x):
    return torch.sigmoid(x)
def _layernorm(x, axis=-1, eps=1e-5):
    m = x.mean(dim=axis, keepdim=True)
    v = x.var(dim=axis, keepdim=True, unbiased=False)
    return (x - m) / torch.sqrt(v + eps)
def _scatter_add(tgt, idx, src, axis=0):
    return tgt.clone().index_add_(axis, idx, src)
def _segment_sum(src, seg, n):
    out = torch.zeros((n,) + src.shape[1:], dtype=src.dtype)
    return out.index_add_(0, seg, src)
def _pad(x, pw):
    flat = tuple(v for pair in reversed(pw) for v in pair)
    return torch.nn.functional.pad(x, flat)

kernel_name = 'standalone__mha_block_cached__near_ridge'

def setup_inputs():

    _w = (lambda a: (lambda t: t.to(torch.bfloat16) if t.is_floating_point() else t)(torch.as_tensor(a)))
    B, Sq, D = 16, 48, 640
    H, Sk, Dh = 32, 48, 128
    return {
        "x": _w((lambda *s: torch.randn(*s, dtype=torch.bfloat16) * 0.8)(B, Sq, D)),
        "k_cache": _w((lambda *s: torch.randn(*s, dtype=torch.bfloat16) * 0.8)(B, H, Sk, Dh)),
        "v_cache": _w((lambda *s: torch.randn(*s, dtype=torch.bfloat16) * 0.05)(B, H, Sk, Dh)),
        "wq": _w((lambda *s: torch.randn(*s, dtype=torch.bfloat16) * 0.8)(D, H * Dh) * (D ** -0.5)),
        "wo": _w((lambda *s: torch.randn(*s, dtype=torch.bfloat16) * 0.05)(H * Dh, D) * ((H * Dh) ** -0.5)),
    }

def reference(x, k_cache, v_cache, wq, wo):
    B, Sq, D = x.shape
    H, Dh = 32, 128
    q = (lambda x, *d: x.permute(*d))((x @ wq).reshape(B, Sq, H, Dh), 0, 2, 1, 3)
    scores = torch.einsum("bhqd,bhkd->bhqk", q, k_cache) * (Dh ** -0.5)
    p = _softmax(scores, axis=-1)
    o = torch.einsum("bhqk,bhkd->bhqd", p, v_cache)
    return (lambda x, *d: x.permute(*d))(o, 0, 2, 1, 3).reshape(B, Sq, H * Dh) @ wo
```

```asm
; @launch grid=(256,1,1) block=(448,1,1) lds=163840
.amdgcn_target "amdgcn-amd-amdhsa--gfx950"
.text
.globl standalone__mha_block_cached__near_ridge_kernel
.p2align 12
.p2align 8
.type standalone__mha_block_cached__near_ridge_kernel,@function
standalone__mha_block_cached__near_ridge_kernel:
    s_cmp_ge_u32 s2, 256
    s_cbranch_scc1 L_end
    s_load_dwordx8 s[40:47], s[0:1], 0
    s_load_dwordx4 s[4:7], s[0:1], 32
    s_load_dwordx2 s[60:61], s[0:1], 48
    s_load_dwordx2 s[48:49], s[0:1], 56
    v_lshrrev_b32 v4, 6, v0
    v_and_b32 v1, 63, v0
    v_readfirstlane_b32 s30, v4
    v_lshrrev_b32 v2, 4, v1
    v_and_b32 v3, 15, v1
    s_and_b32 s33, s2, 7
    s_lshl_b32 s33, s33, 2
    s_bfe_u32 s34, s2, 0x20003
    s_add_u32 s28, s33, s34
    s_lshr_b32 s29, s2, 5
    s_cmp_eq_u32 s30, 4
    s_cbranch_scc1 L_prod
    s_cmp_lg_u32 s30, 6
    s_cbranch_scc1 L_notprod
    s_getpc_b64 s[56:57]
L_pcref:
    s_bfe_u32 s33, s2, 0x30003
    s_mul_i32 s33, s33, 24
    v_min_u32 v4, 23, v1
    v_add_u32 v4, s33, v4
    v_lshlrev_b32 v4, 7, v4
    v_min_u32 v4, L_codeend-L_pcref-4, v4
    global_load_dword v31, v4, s[56:57]
    s_branch L_notprod
L_prod:
    s_setprio 3
    s_mul_i32 s33, s34, 5
    s_add_u32 s33, s33, 1
    s_lshr_b32 s33, s33, 1
    s_add_u32 s35, s33, s29
    s_and_b32 s33, s2, 7
    s_add_u32 s35, s35, s33
    s_cmp_ge_u32 s35, 10
    s_cselect_b32 s33, 10, 0
    s_sub_u32 s35, s35, s33
    s_cmp_ge_u32 s35, 10
    s_cselect_b32 s33, 10, 0
    s_sub_u32 s35, s35, s33
    s_lshl_b32 s36, s35, 19
    s_lshl_b32 s37, s35, 7
    s_lshl_b32 s33, s28, 8
    v_lshlrev_b32 v4, 1, v2
    v_xor_b32 v4, v4, v3
    v_lshlrev_b32 v4, 4, v4
    v_lshl_add_u32 v12, v2, 13, v4
    v_add_u32 v12, s33, v12
    v_add_u32 v13, 31744, v12
    v_xor_b32 v14, 0x80, v12
    v_add_u32 v15, 95232, v14
    v_add_u32 v14, 63488, v14
    s_mul_i32 s33, s29, 122880
    v_lshrrev_b32 v5, 3, v1
    v_and_b32 v6, 7, v1
    v_xor_b32 v6, v6, v5
    v_lshlrev_b32 v6, 4, v6
    v_mul_u32_u24 v16, 1280, v5
    v_add3_u32 v16, v16, v6, s33
    v_add_u32 v17, 9216, v16
    v_add_u32 v18, 18432, v16
    v_add_u32 v19, 27648, v16
    s_waitcnt lgkmcnt(0)
    s_mov_b32 s20, s46
    s_and_b32 s21, s47, 0xffff
    s_mov_b32 s22, 5242880
    s_mov_b32 s23, 0x20000
    s_mov_b32 s8, s40
    s_and_b32 s9, s41, 0xffff
    s_mov_b32 s10, 983040
    s_mov_b32 s11, 0x20000
    s_mov_b32 s31, 0
    s_mov_b32 s32, 0
    s_add_u32 m0, s31, 12288
    s_add_u32 s33, s36, 0
    buffer_load_dwordx4 v12, s[20:23], s33 offen offset:0  lds
    buffer_load_dwordx4 v13, s[20:23], s33 offen offset:1024  lds
    buffer_load_dwordx4 v14, s[20:23], s33 offen offset:2048  lds
    buffer_load_dwordx4 v15, s[20:23], s33 offen offset:3072  lds
    s_add_u32 m0, s31, 16384
    s_add_u32 s33, s36, 131072
    buffer_load_dwordx4 v12, s[20:23], s33 offen offset:0  lds
    buffer_load_dwordx4 v13, s[20:23], s33 offen offset:1024  lds
    buffer_load_dwordx4 v14, s[20:23], s33 offen offset:2048  lds
    buffer_load_dwordx4 v15, s[20:23], s33 offen offset:3072  lds
    s_add_u32 m0, s31, 20480
    s_add_u32 s33, s36, 262144
    buffer_load_dwordx4 v12, s[20:23], s33 offen offset:0  lds
    buffer_load_dwordx4 v13, s[20:23], s33 offen offset:1024  lds
    buffer_load_dwordx4 v14, s[20:23], s33 offen offset:2048  lds
    buffer_load_dwordx4 v15, s[20:23], s33 offen offset:3072  lds
    s_add_u32 m0, s31, 24576
    s_add_u32 s33, s36, 393216
    buffer_load_dwordx4 v12, s[20:23], s33 offen offset:0  lds
    buffer_load_dwordx4 v13, s[20:23], s33 offen offset:1024  lds
    buffer_load_dwordx4 v14, s[20:23], s33 offen offset:2048  lds
    buffer_load_dwordx4 v15, s[20:23], s33 offen offset:3072  lds
    s_add_u32 m0, s31, 0
    s_add_u32 s33, s37, 0
    buffer_load_dwordx4 v16, s[8:11], s33 offen offset:0  lds
    buffer_load_dwordx4 v17, s[8:11], s33 offen offset:1024  lds
    buffer_load_dwordx4 v18, s[8:11], s33 offen offset:2048  lds
    buffer_load_dwordx4 v19, s[8:11], s33 offen offset:3072  lds
    s_add_u32 m0, s31, 4096
    s_add_u32 s33, s37, 40960
    buffer_load_dwordx4 v16, s[8:11], s33 offen offset:0  lds
    buffer_load_dwordx4 v17, s[8:11], s33 offen offset:1024  lds
    buffer_load_dwordx4 v18, s[8:11], s33 offen offset:2048  lds
    buffer_load_dwordx4 v19, s[8:11], s33 offen offset:3072  lds
    s_add_u32 m0, s31, 8192
    s_add_u32 s33, s37, 81920
    buffer_load_dwordx4 v16, s[8:11], s33 offen offset:0  lds
    buffer_load_dwordx4 v17, s[8:11], s33 offen offset:1024  lds
    buffer_load_dwordx4 v18, s[8:11], s33 offen offset:2048  lds
    buffer_load_dwordx4 v19, s[8:11], s33 offen offset:3072  lds
    s_add_u32 s36, s36, 524288
    s_add_u32 s37, s37, 128
    s_cmp_ge_u32 s37, 1280
    s_cselect_b32 s36, 0, s36
    s_cselect_b32 s37, 0, s37
    s_add_u32 s31, s31, 28672
    s_cmp_ge_u32 s31, 114688
    s_cselect_b32 s31, 0, s31
    s_add_u32 s32, s32, 1
    s_mov_b32 s12, s42
    s_and_b32 s13, s43, 0xffff
    s_mov_b32 s14, 6291456
    s_mov_b32 s15, 0x20000
    s_mov_b32 s16, s44
    s_and_b32 s17, s45, 0xffff
    s_mov_b32 s18, 6291456
    s_mov_b32 s19, 0x20000
    s_lshl_b32 s38, s29, 6
    s_add_u32 s38, s38, s28
    s_mul_i32 s38, s38, 12288
    v_xor_b32 v5, v3, v2
    v_lshlrev_b32 v5, 4, v5
    v_lshl_add_u32 v20, v2, 8, v5
    v_xor_b32 v21, 64, v20
    v_xor_b32 v22, 128, v20
    v_xor_b32 v23, 192, v20
    v_lshl_add_u32 v24, v2, 8, v4
    v_xor_b32 v25, 128, v24
    s_lshl_b32 s33, s29, 2
    s_lshr_b32 s39, 2252506690, s33
    s_and_b32 s39, s39, 0xf
    s_mov_b32 s56, s4
    s_and_b32 s57, s5, 0xffff
    s_mov_b32 s58, 5242880
    s_mov_b32 s59, 0x20000
    s_mov_b32 s24, s48
    s_and_b32 s25, s49, 0xffff
    s_mov_b32 s26, 18874368
    s_mov_b32 s27, 0x20000
    s_mov_b32 s52, s60
    s_and_b32 s53, s61, 0xffff
    s_mov_b32 s54, 256
    s_mov_b32 s55, 0x20000
    s_mov_b64 s[46:47], s[6:7]
    s_lshr_b32 s33, s2, 3
    s_mul_i32 s6, s33, 52
    s_lshr_b32 s6, s6, 8
    s_mul_i32 s7, s6, 5
    s_sub_u32 s7, s33, s7
    s_and_b32 s51, s2, 7
    s_mul_i32 s33, s51, 655360
    s_lshl_b32 s34, s7, 8
    s_add_u32 s33, s33, s34
    v_mul_u32_u24 v28, 1280, v2
    v_add3_u32 v28, v28, v4, s33
    v_xor_b32 v29, 0x80, v28
    v_add_u32 v30, 8192, v28
    v_add_u32 v31, 12288, v29
    v_add_u32 v29, 4096, v29
    s_lshl_b32 s33, s6, 10
    s_lshl_b32 s34, s51, 4
    s_add_u32 s33, s33, s34
    s_lshl_b32 s33, s33, 10
    v_lshlrev_b32 v32, 4, v1
    v_add_u32 v32, s33, v32
    s_mul_i32 s33, s6, 43
    s_lshr_b32 s33, s33, 5
    s_mul_i32 s42, s33, 6
    s_add_u32 s42, s42, 6
    s_lshl_b32 s34, s6, 3
    s_sub_u32 s42, s42, s34
    s_lshl_b32 s33, s6, 8
    s_lshl_b32 s34, s51, 2
    s_add_u32 s33, s33, s34
    v_bfe_u32 v36, v1, 2, 3
    v_and_b32 v38, 3, v1
    v_lshl_add_u32 v36, v36, 5, v38
    v_add_u32 v36, s33, v36
    v_lshlrev_b32 v36, 7, v36
    s_and_b32 s40, s6, 3
    s_lshl_b32 s50, s40, 2
    s_lshl_b32 s40, s40, 12
    s_add_u32 s41, s51, 1
    s_and_b32 s41, s41, 7
    s_mov_b32 s44, 0
    s_branch L_ghead0
L_gissue:
    s_add_u32 m0, s31, 12288
    s_add_u32 s33, s36, 0
    buffer_load_dwordx4 v12, s[20:23], s33 offen offset:0  lds
    buffer_load_dwordx4 v13, s[20:23], s33 offen offset:1024  lds
    buffer_load_dwordx4 v14, s[20:23], s33 offen offset:2048  lds
    buffer_load_dwordx4 v15, s[20:23], s33 offen offset:3072  lds
    s_add_u32 m0, s31, 16384
    s_add_u32 s33, s36, 131072
    buffer_load_dwordx4 v12, s[20:23], s33 offen offset:0  lds
    buffer_load_dwordx4 v13, s[20:23], s33 offen offset:1024  lds
    buffer_load_dwordx4 v14, s[20:23], s33 offen offset:2048  lds
    buffer_load_dwordx4 v15, s[20:23], s33 offen offset:3072  lds
    s_add_u32 m0, s31, 20480
    s_add_u32 s33, s36, 262144
    buffer_load_dwordx4 v12, s[20:23], s33 offen offset:0  lds
    buffer_load_dwordx4 v13, s[20:23], s33 offen offset:1024  lds
    buffer_load_dwordx4 v14, s[20:23], s33 offen offset:2048  lds
    buffer_load_dwordx4 v15, s[20:23], s33 offen offset:3072  lds
    s_add_u32 m0, s31, 24576
    s_add_u32 s33, s36, 393216
    buffer_load_dwordx4 v12, s[20:23], s33 offen offset:0  lds
    buffer_load_dwordx4 v13, s[20:23], s33 offen offset:1024  lds
    buffer_load_dwordx4 v14, s[20:23], s33 offen offset:2048  lds
    buffer_load_dwordx4 v15, s[20:23], s33 offen offset:3072  lds
    s_add_u32 m0, s31, 0
    s_add_u32 s33, s37, 0
    buffer_load_dwordx4 v16, s[8:11], s33 offen offset:0  lds
    buffer_load_dwordx4 v17, s[8:11], s33 offen offset:1024  lds
    buffer_load_dwordx4 v18, s[8:11], s33 offen offset:2048  lds
    buffer_load_dwordx4 v19, s[8:11], s33 offen offset:3072  lds
    s_add_u32 m0, s31, 4096
    s_add_u32 s33, s37, 40960
    buffer_load_dwordx4 v16, s[8:11], s33 offen offset:0  lds
    buffer_load_dwordx4 v17, s[8:11], s33 offen offset:1024  lds
    buffer_load_dwordx4 v18, s[8:11], s33 offen offset:2048  lds
    buffer_load_dwordx4 v19, s[8:11], s33 offen offset:3072  lds
    s_add_u32 m0, s31, 8192
    s_add_u32 s33, s37, 81920
    buffer_load_dwordx4 v16, s[8:11], s33 offen offset:0  lds
    buffer_load_dwordx4 v17, s[8:11], s33 offen offset:1024  lds
    buffer_load_dwordx4 v18, s[8:11], s33 offen offset:2048  lds
    buffer_load_dwordx4 v19, s[8:11], s33 offen offset:3072  lds
    s_add_u32 s36, s36, 524288
    s_add_u32 s37, s37, 128
    s_cmp_ge_u32 s37, 1280
    s_cselect_b32 s36, 0, s36
    s_cselect_b32 s37, 0, s37
    s_add_u32 s31, s31, 28672
    s_cmp_ge_u32 s31, 114688
    s_cselect_b32 s31, 0, s31
    s_add_u32 s32, s32, 1
    s_cmp_eq_u32 s32, 10
    s_cbranch_scc1 L_pdone
L_ghead0:
    s_cmp_eq_u32 s32, 1
    s_cbranch_scc1 L_gissue
    s_sub_u32 s33, s32, s39
    s_cmp_eq_u32 s33, 1
    s_cbranch_scc1 L_kvwait
    s_waitcnt vmcnt(28)
    s_barrier
    s_cmp_lg_u32 s32, s39
    s_cbranch_scc1 L_gissue
    s_lshl_b32 s33, s2, 12
    s_add_u32 s33, s33, 17825792
    v_and_b32 v40, 31, v1
    v_lshlrev_b32 v40, 7, v40
    buffer_load_dword v41, v40, s[24:27], s33 offen sc1
    s_mul_i32 s33, s29, 192
    s_add_u32 s33, s33, s28
    s_lshl_b32 s33, s33, 7
    s_add_u32 s33, s33, 16777216
    v_min_u32 v40, 5, v1
    v_lshlrev_b32 v40, 12, v40
    buffer_load_dword v41, v40, s[24:27], s33 offen sc1
    s_mov_b32 m0, 114688
    s_add_u32 s33, s38, 0
    buffer_load_dwordx4 v20, s[12:15], s33 offen offset:0  lds
    buffer_load_dwordx4 v21, s[12:15], s33 offen offset:1024  lds
    buffer_load_dwordx4 v22, s[12:15], s33 offen offset:2048  lds
    buffer_load_dwordx4 v23, s[12:15], s33 offen offset:3072  lds
    s_mov_b32 m0, 118784
    s_add_u32 s33, s38, 4096
    buffer_load_dwordx4 v20, s[12:15], s33 offen offset:0  lds
    buffer_load_dwordx4 v21, s[12:15], s33 offen offset:1024  lds
    buffer_load_dwordx4 v22, s[12:15], s33 offen offset:2048  lds
    buffer_load_dwordx4 v23, s[12:15], s33 offen offset:3072  lds
    s_mov_b32 m0, 122880
    s_add_u32 s33, s38, 8192
    buffer_load_dwordx4 v20, s[12:15], s33 offen offset:0  lds
    buffer_load_dwordx4 v21, s[12:15], s33 offen offset:1024  lds
    buffer_load_dwordx4 v22, s[12:15], s33 offen offset:2048  lds
    buffer_load_dwordx4 v23, s[12:15], s33 offen offset:3072  lds
    s_mov_b32 m0, 126976
    s_add_u32 s33, s38, 393216
    buffer_load_dwordx4 v20, s[12:15], s33 offen offset:0  lds
    buffer_load_dwordx4 v21, s[12:15], s33 offen offset:1024  lds
    buffer_load_dwordx4 v22, s[12:15], s33 offen offset:2048  lds
    buffer_load_dwordx4 v23, s[12:15], s33 offen offset:3072  lds
    s_mov_b32 m0, 131072
    s_add_u32 s33, s38, 397312
    buffer_load_dwordx4 v20, s[12:15], s33 offen offset:0  lds
    buffer_load_dwordx4 v21, s[12:15], s33 offen offset:1024  lds
    buffer_load_dwordx4 v22, s[12:15], s33 offen offset:2048  lds
    buffer_load_dwordx4 v23, s[12:15], s33 offen offset:3072  lds
    s_mov_b32 m0, 135168
    s_add_u32 s33, s38, 401408
    buffer_load_dwordx4 v20, s[12:15], s33 offen offset:0  lds
    buffer_load_dwordx4 v21, s[12:15], s33 offen offset:1024  lds
    buffer_load_dwordx4 v22, s[12:15], s33 offen offset:2048  lds
    buffer_load_dwordx4 v23, s[12:15], s33 offen offset:3072  lds
    s_mov_b32 m0, 139264
    s_add_u32 s33, s38, 0
    buffer_load_dwordx4 v24, s[16:19], s33 offen offset:0  lds
    buffer_load_dwordx4 v25, s[16:19], s33 offen offset:1024  lds
    buffer_load_dwordx4 v24, s[16:19], s33 offen offset:2048  lds
    buffer_load_dwordx4 v25, s[16:19], s33 offen offset:3072  lds
    s_mov_b32 m0, 143360
    s_add_u32 s33, s38, 4096
    buffer_load_dwordx4 v24, s[16:19], s33 offen offset:0  lds
    buffer_load_dwordx4 v25, s[16:19], s33 offen offset:1024  lds
    buffer_load_dwordx4 v24, s[16:19], s33 offen offset:2048  lds
    buffer_load_dwordx4 v25, s[16:19], s33 offen offset:3072  lds
    s_mov_b32 m0, 147456
    s_add_u32 s33, s38, 8192
    buffer_load_dwordx4 v24, s[16:19], s33 offen offset:0  lds
    buffer_load_dwordx4 v25, s[16:19], s33 offen offset:1024  lds
    buffer_load_dwordx4 v24, s[16:19], s33 offen offset:2048  lds
    buffer_load_dwordx4 v25, s[16:19], s33 offen offset:3072  lds
    s_mov_b32 m0, 151552
    s_add_u32 s33, s38, 393216
    buffer_load_dwordx4 v24, s[16:19], s33 offen offset:0  lds
    buffer_load_dwordx4 v25, s[16:19], s33 offen offset:1024  lds
    buffer_load_dwordx4 v24, s[16:19], s33 offen offset:2048  lds
    buffer_load_dwordx4 v25, s[16:19], s33 offen offset:3072  lds
    s_mov_b32 m0, 155648
    s_add_u32 s33, s38, 397312
    buffer_load_dwordx4 v24, s[16:19], s33 offen offset:0  lds
    buffer_load_dwordx4 v25, s[16:19], s33 offen offset:1024  lds
    buffer_load_dwordx4 v24, s[16:19], s33 offen offset:2048  lds
    buffer_load_dwordx4 v25, s[16:19], s33 offen offset:3072  lds
    s_mov_b32 m0, 159744
    s_add_u32 s33, s38, 401408
    buffer_load_dwordx4 v24, s[16:19], s33 offen offset:0  lds
    buffer_load_dwordx4 v25, s[16:19], s33 offen offset:1024  lds
    buffer_load_dwordx4 v24, s[16:19], s33 offen offset:2048  lds
    buffer_load_dwordx4 v25, s[16:19], s33 offen offset:3072  lds
    s_waitcnt vmcnt(48)
    s_barrier
    s_branch L_gissue
L_kvwait:
    s_waitcnt vmcnt(52)
    s_barrier
    s_waitcnt vmcnt(28)
    s_barrier
    s_branch L_gissue
L_pdone:
    s_waitcnt vmcnt(28)
    s_barrier
    s_load_dword s3, s[60:61], 0
    s_cmp_ge_u32 s2, 240
    s_cbranch_scc1 L_prod_notile
    s_mul_i32 s34, s50, 40960
    s_mov_b32 m0, 57344
    s_add_u32 s33, s34, 0
    buffer_load_dwordx4 v28, s[56:59], s33 offen offset:0  lds
    buffer_load_dwordx4 v29, s[56:59], s33 offen offset:1024  lds
    buffer_load_dwordx4 v30, s[56:59], s33 offen offset:2048  lds
    buffer_load_dwordx4 v31, s[56:59], s33 offen offset:3072  lds
    s_mov_b32 m0, 61440
    s_add_u32 s33, s34, 20480
    buffer_load_dwordx4 v28, s[56:59], s33 offen offset:0  lds
    buffer_load_dwordx4 v29, s[56:59], s33 offen offset:1024  lds
    buffer_load_dwordx4 v30, s[56:59], s33 offen offset:2048  lds
    buffer_load_dwordx4 v31, s[56:59], s33 offen offset:3072  lds
    s_add_u32 s50, s50, 1
    s_and_b32 s50, s50, 15
    s_mul_i32 s34, s50, 40960
    s_mov_b32 m0, 65536
    s_add_u32 s33, s34, 0
    buffer_load_dwordx4 v28, s[56:59], s33 offen offset:0  lds
    buffer_load_dwordx4 v29, s[56:59], s33 offen offset:1024  lds
    buffer_load_dwordx4 v30, s[56:59], s33 offen offset:2048  lds
    buffer_load_dwordx4 v31, s[56:59], s33 offen offset:3072  lds
    s_mov_b32 m0, 69632
    s_add_u32 s33, s34, 20480
    buffer_load_dwordx4 v28, s[56:59], s33 offen offset:0  lds
    buffer_load_dwordx4 v29, s[56:59], s33 offen offset:1024  lds
    buffer_load_dwordx4 v30, s[56:59], s33 offen offset:2048  lds
    buffer_load_dwordx4 v31, s[56:59], s33 offen offset:3072  lds
    s_add_u32 s50, s50, 1
    s_and_b32 s50, s50, 15
    s_mul_i32 s34, s50, 40960
    s_mov_b32 m0, 73728
    s_add_u32 s33, s34, 0
    buffer_load_dwordx4 v28, s[56:59], s33 offen offset:0  lds
    buffer_load_dwordx4 v29, s[56:59], s33 offen offset:1024  lds
    buffer_load_dwordx4 v30, s[56:59], s33 offen offset:2048  lds
    buffer_load_dwordx4 v31, s[56:59], s33 offen offset:3072  lds
    s_mov_b32 m0, 77824
    s_add_u32 s33, s34, 20480
    buffer_load_dwordx4 v28, s[56:59], s33 offen offset:0  lds
    buffer_load_dwordx4 v29, s[56:59], s33 offen offset:1024  lds
    buffer_load_dwordx4 v30, s[56:59], s33 offen offset:2048  lds
    buffer_load_dwordx4 v31, s[56:59], s33 offen offset:3072  lds
    s_add_u32 s50, s50, 1
    s_and_b32 s50, s50, 15
    s_mul_i32 s34, s50, 40960
    s_mov_b32 m0, 81920
    s_add_u32 s33, s34, 0
    buffer_load_dwordx4 v28, s[56:59], s33 offen offset:0  lds
    buffer_load_dwordx4 v29, s[56:59], s33 offen offset:1024  lds
    buffer_load_dwordx4 v30, s[56:59], s33 offen offset:2048  lds
    buffer_load_dwordx4 v31, s[56:59], s33 offen offset:3072  lds
    s_mov_b32 m0, 86016
    s_add_u32 s33, s34, 20480
    buffer_load_dwordx4 v28, s[56:59], s33 offen offset:0  lds
    buffer_load_dwordx4 v29, s[56:59], s33 offen offset:1024  lds
    buffer_load_dwordx4 v30, s[56:59], s33 offen offset:2048  lds
    buffer_load_dwordx4 v31, s[56:59], s33 offen offset:3072  lds
    s_add_u32 s50, s50, 1
    s_and_b32 s50, s50, 15
    s_waitcnt vmcnt(32)
    s_barrier
    s_waitcnt lgkmcnt(0)
    s_mov_b32 s37, 0
L1:
    s_cmp_lg_u32 s3, 0
    s_cbranch_scc1 L2
    s_cmp_gt_u32 s37, 400000
    s_cbranch_scc1 L2
    buffer_load_dword v37, off, s[52:55], 0 sc1
    s_add_u32 s37, s37, 1
    s_waitcnt vmcnt(0)
    v_readfirstlane_b32 s3, v37
    s_nop 0
    s_branch L1
L2:
    s_barrier
    s_branch L_pgB
    .p2align 12
L_stubB:
    s_setpc_b64 s[4:5]
L_pgB:
    s_barrier
    s_mul_i32 s34, s50, 40960
    s_mov_b32 m0, 0
    s_add_u32 s33, s34, 0
    buffer_load_dwordx4 v28, s[56:59], s33 offen offset:0  lds
    buffer_load_dwordx4 v29, s[56:59], s33 offen offset:1024  lds
    buffer_load_dwordx4 v30, s[56:59], s33 offen offset:2048  lds
    buffer_load_dwordx4 v31, s[56:59], s33 offen offset:3072  lds
    s_mov_b32 m0, 4096
    s_add_u32 s33, s34, 20480
    buffer_load_dwordx4 v28, s[56:59], s33 offen offset:0  lds
    buffer_load_dwordx4 v29, s[56:59], s33 offen offset:1024  lds
    buffer_load_dwordx4 v30, s[56:59], s33 offen offset:2048  lds
    buffer_load_dwordx4 v31, s[56:59], s33 offen offset:3072  lds
    s_add_u32 s50, s50, 1
    s_and_b32 s50, s50, 15
    s_mul_i32 s34, s50, 40960
    s_mov_b32 m0, 8192
    s_add_u32 s33, s34, 0
    buffer_load_dwordx4 v28, s[56:59], s33 offen offset:0  lds
    buffer_load_dwordx4 v29, s[56:59], s33 offen offset:1024  lds
    buffer_load_dwordx4 v30, s[56:59], s33 offen offset:2048  lds
    buffer_load_dwordx4 v31, s[56:59], s33 offen offset:3072  lds
    s_mov_b32 m0, 12288
    s_add_u32 s33, s34, 20480
    buffer_load_dwordx4 v28, s[56:59], s33 offen offset:0  lds
    buffer_load_dwordx4 v29, s[56:59], s33 offen offset:1024  lds
    buffer_load_dwordx4 v30, s[56:59], s33 offen offset:2048  lds
    buffer_load_dwordx4 v31, s[56:59], s33 offen offset:3072  lds
    s_add_u32 s50, s50, 1
    s_and_b32 s50, s50, 15
    s_mul_i32 s34, s50, 40960
    s_mov_b32 m0, 16384
    s_add_u32 s33, s34, 0
    buffer_load_dwordx4 v28, s[56:59], s33 offen offset:0  lds
    buffer_load_dwordx4 v29, s[56:59], s33 offen offset:1024  lds
    buffer_load_dwordx4 v30, s[56:59], s33 offen offset:2048  lds
    buffer_load_dwordx4 v31, s[56:59], s33 offen offset:3072  lds
    s_mov_b32 m0, 20480
    s_add_u32 s33, s34, 20480
    buffer_load_dwordx4 v28, s[56:59], s33 offen offset:0  lds
    buffer_load_dwordx4 v29, s[56:59], s33 offen offset:1024  lds
    buffer_load_dwordx4 v30, s[56:59], s33 offen offset:2048  lds
    buffer_load_dwordx4 v31, s[56:59], s33 offen offset:3072  lds
    s_add_u32 s50, s50, 1
    s_and_b32 s50, s50, 15
    s_mul_i32 s34, s50, 40960
    s_mov_b32 m0, 24576
    s_add_u32 s33, s34, 0
    buffer_load_dwordx4 v28, s[56:59], s33 offen offset:0  lds
    buffer_load_dwordx4 v29, s[56:59], s33 offen offset:1024  lds
    buffer_load_dwordx4 v30, s[56:59], s33 offen offset:2048  lds
    buffer_load_dwordx4 v31, s[56:59], s33 offen offset:3072  lds
    s_mov_b32 m0, 28672
    s_add_u32 s33, s34, 20480
    buffer_load_dwordx4 v28, s[56:59], s33 offen offset:0  lds
    buffer_load_dwordx4 v29, s[56:59], s33 offen offset:1024  lds
    buffer_load_dwordx4 v30, s[56:59], s33 offen offset:2048  lds
    buffer_load_dwordx4 v31, s[56:59], s33 offen offset:3072  lds
    s_add_u32 s50, s50, 1
    s_and_b32 s50, s50, 15
    s_mul_i32 s34, s50, 40960
    s_mov_b32 m0, 32768
    s_add_u32 s33, s34, 0
    buffer_load_dwordx4 v28, s[56:59], s33 offen offset:0  lds
    buffer_load_dwordx4 v29, s[56:59], s33 offen offset:1024  lds
    buffer_load_dwordx4 v30, s[56:59], s33 offen offset:2048  lds
    buffer_load_dwordx4 v31, s[56:59], s33 offen offset:3072  lds
    s_mov_b32 m0, 36864
    s_add_u32 s33, s34, 20480
    buffer_load_dwordx4 v28, s[56:59], s33 offen offset:0  lds
    buffer_load_dwordx4 v29, s[56:59], s33 offen offset:1024  lds
    buffer_load_dwordx4 v30, s[56:59], s33 offen offset:2048  lds
    buffer_load_dwordx4 v31, s[56:59], s33 offen offset:3072  lds
    s_add_u32 s50, s50, 1
    s_and_b32 s50, s50, 15
    s_mul_i32 s34, s50, 40960
    s_mov_b32 m0, 40960
    s_add_u32 s33, s34, 0
    buffer_load_dwordx4 v28, s[56:59], s33 offen offset:0  lds
    buffer_load_dwordx4 v29, s[56:59], s33 offen offset:1024  lds
    buffer_load_dwordx4 v30, s[56:59], s33 offen offset:2048  lds
    buffer_load_dwordx4 v31, s[56:59], s33 offen offset:3072  lds
    s_mov_b32 m0, 45056
    s_add_u32 s33, s34, 20480
    buffer_load_dwordx4 v28, s[56:59], s33 offen offset:0  lds
    buffer_load_dwordx4 v29, s[56:59], s33 offen offset:1024  lds
    buffer_load_dwordx4 v30, s[56:59], s33 offen offset:2048  lds
    buffer_load_dwordx4 v31, s[56:59], s33 offen offset:3072  lds
    s_add_u32 s50, s50, 1
    s_and_b32 s50, s50, 15
    s_mul_i32 s34, s50, 40960
    s_mov_b32 m0, 49152
    s_add_u32 s33, s34, 0
    buffer_load_dwordx4 v28, s[56:59], s33 offen offset:0  lds
    buffer_load_dwordx4 v29, s[56:59], s33 offen offset:1024  lds
    buffer_load_dwordx4 v30, s[56:59], s33 offen offset:2048  lds
    buffer_load_dwordx4 v31, s[56:59], s33 offen offset:3072  lds
    s_mov_b32 m0, 53248
    s_add_u32 s33, s34, 20480
    buffer_load_dwordx4 v28, s[56:59], s33 offen offset:0  lds
    buffer_load_dwordx4 v29, s[56:59], s33 offen offset:1024  lds
    buffer_load_dwordx4 v30, s[56:59], s33 offen offset:2048  lds
    buffer_load_dwordx4 v31, s[56:59], s33 offen offset:3072  lds
    s_add_u32 s50, s50, 1
    s_and_b32 s50, s50, 15
    s_mul_i32 s34, s50, 40960
    s_mov_b32 m0, 114688
    s_add_u32 s33, s34, 0
    buffer_load_dwordx4 v28, s[56:59], s33 offen offset:0  lds
    buffer_load_dwordx4 v29, s[56:59], s33 offen offset:1024  lds
    buffer_load_dwordx4 v30, s[56:59], s33 offen offset:2048  lds
    buffer_load_dwordx4 v31, s[56:59], s33 offen offset:3072  lds
    s_mov_b32 m0, 118784
    s_add_u32 s33, s34, 20480
    buffer_load_dwordx4 v28, s[56:59], s33 offen offset:0  lds
    buffer_load_dwordx4 v29, s[56:59], s33 offen offset:1024  lds
    buffer_load_dwordx4 v30, s[56:59], s33 offen offset:2048  lds
    buffer_load_dwordx4 v31, s[56:59], s33 offen offset:3072  lds
    s_add_u32 s50, s50, 1
    s_and_b32 s50, s50, 15
    s_waitcnt vmcnt(0)
    s_barrier
    s_mov_b32 s33, 16777216
    buffer_load_dword v39, v36, s[24:27], s33 offen sc1
    s_mul_i32 s34, s50, 40960
    s_mov_b32 m0, 131072
    s_add_u32 s33, s34, 0
    buffer_load_dwordx4 v28, s[56:59], s33 offen offset:0  lds
    buffer_load_dwordx4 v29, s[56:59], s33 offen offset:1024  lds
    buffer_load_dwordx4 v30, s[56:59], s33 offen offset:2048  lds
    buffer_load_dwordx4 v31, s[56:59], s33 offen offset:3072  lds
    s_mov_b32 m0, 135168
    s_add_u32 s33, s34, 20480
    buffer_load_dwordx4 v28, s[56:59], s33 offen offset:0  lds
    buffer_load_dwordx4 v29, s[56:59], s33 offen offset:1024  lds
    buffer_load_dwordx4 v30, s[56:59], s33 offen offset:2048  lds
    buffer_load_dwordx4 v31, s[56:59], s33 offen offset:3072  lds
    s_add_u32 s50, s50, 1
    s_and_b32 s50, s50, 15
    s_mul_i32 s34, s50, 40960
    s_mov_b32 m0, 139264
    s_add_u32 s33, s34, 0
    buffer_load_dwordx4 v28, s[56:59], s33 offen offset:0  lds
    buffer_load_dwordx4 v29, s[56:59], s33 offen offset:1024  lds
    buffer_load_dwordx4 v30, s[56:59], s33 offen offset:2048  lds
    buffer_load_dwordx4 v31, s[56:59], s33 offen offset:3072  lds
    s_mov_b32 m0, 143360
    s_add_u32 s33, s34, 20480
    buffer_load_dwordx4 v28, s[56:59], s33 offen offset:0  lds
    buffer_load_dwordx4 v29, s[56:59], s33 offen offset:1024  lds
    buffer_load_dwordx4 v30, s[56:59], s33 offen offset:2048  lds
    buffer_load_dwordx4 v31, s[56:59], s33 offen offset:3072  lds
    s_add_u32 s50, s50, 1
    s_and_b32 s50, s50, 15
    s_mul_i32 s34, s50, 40960
    s_mov_b32 m0, 147456
    s_add_u32 s33, s34, 0
    buffer_load_dwordx4 v28, s[56:59], s33 offen offset:0  lds
    buffer_load_dwordx4 v29, s[56:59], s33 offen offset:1024  lds
    buffer_load_dwordx4 v30, s[56:59], s33 offen offset:2048  lds
    buffer_load_dwordx4 v31, s[56:59], s33 offen offset:3072  lds
    s_mov_b32 m0, 151552
    s_add_u32 s33, s34, 20480
    buffer_load_dwordx4 v28, s[56:59], s33 offen offset:0  lds
    buffer_load_dwordx4 v29, s[56:59], s33 offen offset:1024  lds
    buffer_load_dwordx4 v30, s[56:59], s33 offen offset:2048  lds
    buffer_load_dwordx4 v31, s[56:59], s33 offen offset:3072  lds
    s_add_u32 s50, s50, 1
    s_and_b32 s50, s50, 15
    s_mul_i32 s34, s50, 40960
    s_mov_b32 m0, 155648
    s_add_u32 s33, s34, 0
    buffer_load_dwordx4 v28, s[56:59], s33 offen offset:0  lds
    buffer_load_dwordx4 v29, s[56:59], s33 offen offset:1024  lds
    buffer_load_dwordx4 v30, s[56:59], s33 offen offset:2048  lds
    buffer_load_dwordx4 v31, s[56:59], s33 offen offset:3072  lds
    s_mov_b32 m0, 159744
    s_add_u32 s33, s34, 20480
    buffer_load_dwordx4 v28, s[56:59], s33 offen offset:0  lds
    buffer_load_dwordx4 v29, s[56:59], s33 offen offset:1024  lds
    buffer_load_dwordx4 v30, s[56:59], s33 offen offset:2048  lds
    buffer_load_dwordx4 v31, s[56:59], s33 offen offset:3072  lds
    s_add_u32 s50, s50, 1
    s_and_b32 s50, s50, 15
    s_barrier
    s_waitcnt vmcnt(32)
    v_cmp_eq_u32 s[44:45], s3, v39
    s_nop 1
    s_lshl_b32 s34, s41, 2
    s_lshl_b32 s35, 0xf, s34
    s_andn2_b32 s34, s35, s44
    s_cbranch_scc0 L3
    s_call_b64 s[4:5], L_poll1
L3:
    s_lshl_b32 s34, s41, 17
    s_mov_b32 m0, 0
    s_add_u32 s33, s34, s40
    buffer_load_dwordx4 v32, s[24:27], s33 offen offset:0 sc1 lds
    buffer_load_dwordx4 v32, s[24:27], s33 offen offset:1024 sc1 lds
    buffer_load_dwordx4 v32, s[24:27], s33 offen offset:2048 sc1 lds
    buffer_load_dwordx4 v32, s[24:27], s33 offen offset:3072 sc1 lds
    s_add_u32 s40, s40, 4096
    s_and_b32 s40, s40, 0x3fff
    s_mov_b32 m0, 4096
    s_add_u32 s33, s34, s40
    buffer_load_dwordx4 v32, s[24:27], s33 offen offset:0 sc1 lds
    buffer_load_dwordx4 v32, s[24:27], s33 offen offset:1024 sc1 lds
    buffer_load_dwordx4 v32, s[24:27], s33 offen offset:2048 sc1 lds
    buffer_load_dwordx4 v32, s[24:27], s33 offen offset:3072 sc1 lds
    s_add_u32 s40, s40, 4096
    s_and_b32 s40, s40, 0x3fff
    s_mov_b32 m0, 8192
    s_add_u32 s33, s34, s40
    buffer_load_dwordx4 v32, s[24:27], s33 offen offset:0 sc1 lds
    buffer_load_dwordx4 v32, s[24:27], s33 offen offset:1024 sc1 lds
    buffer_load_dwordx4 v32, s[24:27], s33 offen offset:2048 sc1 lds
    buffer_load_dwordx4 v32, s[24:27], s33 offen offset:3072 sc1 lds
    s_add_u32 s40, s40, 4096
    s_and_b32 s40, s40, 0x3fff
    s_mov_b32 m0, 12288
    s_add_u32 s33, s34, s40
    buffer_load_dwordx4 v32, s[24:27], s33 offen offset:0 sc1 lds
    buffer_load_dwordx4 v32, s[24:27], s33 offen offset:1024 sc1 lds
    buffer_load_dwordx4 v32, s[24:27], s33 offen offset:2048 sc1 lds
    buffer_load_dwordx4 v32, s[24:27], s33 offen offset:3072 sc1 lds
    s_add_u32 s40, s40, 4096
    s_and_b32 s40, s40, 0x3fff
    s_add_u32 s41, s41, 1
    s_and_b32 s41, s41, 7
    s_lshl_b32 s34, s41, 2
    s_lshl_b32 s35, 0xf, s34
    s_andn2_b32 s34, s35, s44
    s_cbranch_scc0 L4
    s_call_b64 s[4:5], L_poll1
L4:
    s_lshl_b32 s34, s41, 17
    s_mov_b32 m0, 16384
    s_add_u32 s33, s34, s40
    buffer_load_dwordx4 v32, s[24:27], s33 offen offset:0 sc1 lds
    buffer_load_dwordx4 v32, s[24:27], s33 offen offset:1024 sc1 lds
    buffer_load_dwordx4 v32, s[24:27], s33 offen offset:2048 sc1 lds
    buffer_load_dwordx4 v32, s[24:27], s33 offen offset:3072 sc1 lds
    s_add_u32 s40, s40, 4096
    s_and_b32 s40, s40, 0x3fff
    s_mov_b32 m0, 20480
    s_add_u32 s33, s34, s40
    buffer_load_dwordx4 v32, s[24:27], s33 offen offset:0 sc1 lds
    buffer_load_dwordx4 v32, s[24:27], s33 offen offset:1024 sc1 lds
    buffer_load_dwordx4 v32, s[24:27], s33 offen offset:2048 sc1 lds
    buffer_load_dwordx4 v32, s[24:27], s33 offen offset:3072 sc1 lds
    s_add_u32 s40, s40, 4096
    s_and_b32 s40, s40, 0x3fff
    s_mov_b32 m0, 24576
    s_add_u32 s33, s34, s40
    buffer_load_dwordx4 v32, s[24:27], s33 offen offset:0 sc1 lds
    buffer_load_dwordx4 v32, s[24:27], s33 offen offset:1024 sc1 lds
    buffer_load_dwordx4 v32, s[24:27], s33 offen offset:2048 sc1 lds
    buffer_load_dwordx4 v32, s[24:27], s33 offen offset:3072 sc1 lds
    s_add_u32 s40, s40, 4096
    s_and_b32 s40, s40, 0x3fff
    s_mov_b32 m0, 28672
    s_add_u32 s33, s34, s40
    buffer_load_dwordx4 v32, s[24:27], s33 offen offset:0 sc1 lds
    buffer_load_dwordx4 v32, s[24:27], s33 offen offset:1024 sc1 lds
    buffer_load_dwordx4 v32, s[24:27], s33 offen offset:2048 sc1 lds
    buffer_load_dwordx4 v32, s[24:27], s33 offen offset:3072 sc1 lds
    s_add_u32 s40, s40, 4096
    s_and_b32 s40, s40, 0x3fff
    s_add_u32 s41, s41, 1
    s_and_b32 s41, s41, 7
    s_lshl_b32 s34, s41, 2
    s_lshl_b32 s35, 0xf, s34
    s_andn2_b32 s34, s35, s44
    s_cbranch_scc0 L5
    s_call_b64 s[4:5], L_poll1
L5:
    s_lshl_b32 s34, s41, 17
    s_mov_b32 m0, 32768
    s_add_u32 s33, s34, s40
    buffer_load_dwordx4 v32, s[24:27], s33 offen offset:0 sc1 lds
    buffer_load_dwordx4 v32, s[24:27], s33 offen offset:1024 sc1 lds
    buffer_load_dwordx4 v32, s[24:27], s33 offen offset:2048 sc1 lds
    buffer_load_dwordx4 v32, s[24:27], s33 offen offset:3072 sc1 lds
    s_add_u32 s40, s40, 4096
    s_and_b32 s40, s40, 0x3fff
    s_mov_b32 m0, 36864
    s_add_u32 s33, s34, s40
    buffer_load_dwordx4 v32, s[24:27], s33 offen offset:0 sc1 lds
    buffer_load_dwordx4 v32, s[24:27], s33 offen offset:1024 sc1 lds
    buffer_load_dwordx4 v32, s[24:27], s33 offen offset:2048 sc1 lds
    buffer_load_dwordx4 v32, s[24:27], s33 offen offset:3072 sc1 lds
    s_add_u32 s40, s40, 4096
    s_and_b32 s40, s40, 0x3fff
    s_mov_b32 m0, 40960
    s_add_u32 s33, s34, s40
    buffer_load_dwordx4 v32, s[24:27], s33 offen offset:0 sc1 lds
    buffer_load_dwordx4 v32, s[24:27], s33 offen offset:1024 sc1 lds
    buffer_load_dwordx4 v32, s[24:27], s33 offen offset:2048 sc1 lds
    buffer_load_dwordx4 v32, s[24:27], s33 offen offset:3072 sc1 lds
    s_add_u32 s40, s40, 4096
    s_and_b32 s40, s40, 0x3fff
    s_mov_b32 m0, 45056
    s_add_u32 s33, s34, s40
    buffer_load_dwordx4 v32, s[24:27], s33 offen offset:0 sc1 lds
    buffer_load_dwordx4 v32, s[24:27], s33 offen offset:1024 sc1 lds
    buffer_load_dwordx4 v32, s[24:27], s33 offen offset:2048 sc1 lds
    buffer_load_dwordx4 v32, s[24:27], s33 offen offset:3072 sc1 lds
    s_add_u32 s40, s40, 4096
    s_and_b32 s40, s40, 0x3fff
    s_add_u32 s41, s41, 1
    s_and_b32 s41, s41, 7
    s_waitcnt vmcnt(32)
    s_barrier
    s_lshl_b32 s34, s41, 2
    s_lshl_b32 s35, 0xf, s34
    s_andn2_b32 s34, s35, s44
    s_cbranch_scc0 L6
    s_call_b64 s[4:5], L_poll1
L6:
    s_lshl_b32 s34, s41, 17
    s_mov_b32 m0, 49152
    s_add_u32 s33, s34, s40
    buffer_load_dwordx4 v32, s[24:27], s33 offen offset:0 sc1 lds
    buffer_load_dwordx4 v32, s[24:27], s33 offen offset:1024 sc1 lds
    buffer_load_dwordx4 v32, s[24:27], s33 offen offset:2048 sc1 lds
    buffer_load_dwordx4 v32, s[24:27], s33 offen offset:3072 sc1 lds
    s_add_u32 s40, s40, 4096
    s_and_b32 s40, s40, 0x3fff
    s_mov_b32 m0, 53248
    s_add_u32 s33, s34, s40
    buffer_load_dwordx4 v32, s[24:27], s33 offen offset:0 sc1 lds
    buffer_load_dwordx4 v32, s[24:27], s33 offen offset:1024 sc1 lds
    buffer_load_dwordx4 v32, s[24:27], s33 offen offset:2048 sc1 lds
    buffer_load_dwordx4 v32, s[24:27], s33 offen offset:3072 sc1 lds
    s_add_u32 s40, s40, 4096
    s_and_b32 s40, s40, 0x3fff
    s_mov_b32 m0, 57344
    s_add_u32 s33, s34, s40
    buffer_load_dwordx4 v32, s[24:27], s33 offen offset:0 sc1 lds
    buffer_load_dwordx4 v32, s[24:27], s33 offen offset:1024 sc1 lds
    buffer_load_dwordx4 v32, s[24:27], s33 offen offset:2048 sc1 lds
    buffer_load_dwordx4 v32, s[24:27], s33 offen offset:3072 sc1 lds
    s_add_u32 s40, s40, 4096
    s_and_b32 s40, s40, 0x3fff
    s_mov_b32 m0, 61440
    s_add_u32 s33, s34, s40
    buffer_load_dwordx4 v32, s[24:27], s33 offen offset:0 sc1 lds
    buffer_load_dwordx4 v32, s[24:27], s33 offen offset:1024 sc1 lds
    buffer_load_dwordx4 v32, s[24:27], s33 offen offset:2048 sc1 lds
    buffer_load_dwordx4 v32, s[24:27], s33 offen offset:3072 sc1 lds
    s_add_u32 s40, s40, 4096
    s_and_b32 s40, s40, 0x3fff
    s_add_u32 s41, s41, 1
    s_and_b32 s41, s41, 7
    s_waitcnt vmcnt(32)
    s_barrier
    s_lshl_b32 s34, s41, 2
    s_lshl_b32 s35, 0xf, s34
    s_andn2_b32 s34, s35, s44
    s_cbranch_scc0 L7
    s_call_b64 s[4:5], L_poll1
L7:
    s_lshl_b32 s34, s41, 17
    s_mov_b32 m0, 65536
    s_add_u32 s33, s34, s40
    buffer_load_dwordx4 v32, s[24:27], s33 offen offset:0 sc1 lds
    buffer_load_dwordx4 v32, s[24:27], s33 offen offset:1024 sc1 lds
    buffer_load_dwordx4 v32, s[24:27], s33 offen offset:2048 sc1 lds
    buffer_load_dwordx4 v32, s[24:27], s33 offen offset:3072 sc1 lds
    s_add_u32 s40, s40, 4096
    s_and_b32 s40, s40, 0x3fff
    s_mov_b32 m0, 69632
    s_add_u32 s33, s34, s40
    buffer_load_dwordx4 v32, s[24:27], s33 offen offset:0 sc1 lds
    buffer_load_dwordx4 v32, s[24:27], s33 offen offset:1024 sc1 lds
    buffer_load_dwordx4 v32, s[24:27], s33 offen offset:2048 sc1 lds
    buffer_load_dwordx4 v32, s[24:27], s33 offen offset:3072 sc1 lds
    s_add_u32 s40, s40, 4096
    s_and_b32 s40, s40, 0x3fff
    s_mov_b32 m0, 73728
    s_add_u32 s33, s34, s40
    buffer_load_dwordx4 v32, s[24:27], s33 offen offset:0 sc1 lds
    buffer_load_dwordx4 v32, s[24:27], s33 offen offset:1024 sc1 lds
    buffer_load_dwordx4 v32, s[24:27], s33 offen offset:2048 sc1 lds
    buffer_load_dwordx4 v32, s[24:27], s33 offen offset:3072 sc1 lds
    s_add_u32 s40, s40, 4096
    s_and_b32 s40, s40, 0x3fff
    s_mov_b32 m0, 77824
    s_add_u32 s33, s34, s40
    buffer_load_dwordx4 v32, s[24:27], s33 offen offset:0 sc1 lds
    buffer_load_dwordx4 v32, s[24:27], s33 offen offset:1024 sc1 lds
    buffer_load_dwordx4 v32, s[24:27], s33 offen offset:2048 sc1 lds
    buffer_load_dwordx4 v32, s[24:27], s33 offen offset:3072 sc1 lds
    s_add_u32 s40, s40, 4096
    s_and_b32 s40, s40, 0x3fff
    s_add_u32 s41, s41, 1
    s_and_b32 s41, s41, 7
    s_waitcnt vmcnt(32)
    s_barrier
    s_lshl_b32 s34, s41, 2
    s_lshl_b32 s35, 0xf, s34
    s_andn2_b32 s34, s35, s44
    s_cbranch_scc0 L8
    s_call_b64 s[4:5], L_poll1
L8:
    s_lshl_b32 s34, s41, 17
    s_mov_b32 m0, 81920
    s_add_u32 s33, s34, s40
    buffer_load_dwordx4 v32, s[24:27], s33 offen offset:0 sc1 lds
    buffer_load_dwordx4 v32, s[24:27], s33 offen offset:1024 sc1 lds
    buffer_load_dwordx4 v32, s[24:27], s33 offen offset:2048 sc1 lds
    buffer_load_dwordx4 v32, s[24:27], s33 offen offset:3072 sc1 lds
    s_add_u32 s40, s40, 4096
    s_and_b32 s40, s40, 0x3fff
    s_mov_b32 m0, 86016
    s_add_u32 s33, s34, s40
    buffer_load_dwordx4 v32, s[24:27], s33 offen offset:0 sc1 lds
    buffer_load_dwordx4 v32, s[24:27], s33 offen offset:1024 sc1 lds
    buffer_load_dwordx4 v32, s[24:27], s33 offen offset:2048 sc1 lds
    buffer_load_dwordx4 v32, s[24:27], s33 offen offset:3072 sc1 lds
    s_add_u32 s40, s40, 4096
    s_and_b32 s40, s40, 0x3fff
    s_mov_b32 m0, 90112
    s_add_u32 s33, s34, s40
    buffer_load_dwordx4 v32, s[24:27], s33 offen offset:0 sc1 lds
    buffer_load_dwordx4 v32, s[24:27], s33 offen offset:1024 sc1 lds
    buffer_load_dwordx4 v32, s[24:27], s33 offen offset:2048 sc1 lds
    buffer_load_dwordx4 v32, s[24:27], s33 offen offset:3072 sc1 lds
    s_add_u32 s40, s40, 4096
    s_and_b32 s40, s40, 0x3fff
    s_mov_b32 m0, 94208
    s_add_u32 s33, s34, s40
    buffer_load_dwordx4 v32, s[24:27], s33 offen offset:0 sc1 lds
    buffer_load_dwordx4 v32, s[24:27], s33 offen offset:1024 sc1 lds
    buffer_load_dwordx4 v32, s[24:27], s33 offen offset:2048 sc1 lds
    buffer_load_dwordx4 v32, s[24:27], s33 offen offset:3072 sc1 lds
    s_add_u32 s40, s40, 4096
    s_and_b32 s40, s40, 0x3fff
    s_add_u32 s41, s41, 1
    s_and_b32 s41, s41, 7
    s_waitcnt vmcnt(32)
    s_barrier
    s_lshl_b32 s34, s41, 2
    s_lshl_b32 s35, 0xf, s34
    s_andn2_b32 s34, s35, s44
    s_cbranch_scc0 L9
    s_call_b64 s[4:5], L_poll1
L9:
    s_lshl_b32 s34, s41, 17
    s_mov_b32 m0, 98304
    s_add_u32 s33, s34, s40
    buffer_load_dwordx4 v32, s[24:27], s33 offen offset:0 sc1 lds
    buffer_load_dwordx4 v32, s[24:27], s33 offen offset:1024 sc1 lds
    buffer_load_dwordx4 v32, s[24:27], s33 offen offset:2048 sc1 lds
    buffer_load_dwordx4 v32, s[24:27], s33 offen offset:3072 sc1 lds
    s_add_u32 s40, s40, 4096
    s_and_b32 s40, s40, 0x3fff
    s_mov_b32 m0, 102400
    s_add_u32 s33, s34, s40
    buffer_load_dwordx4 v32, s[24:27], s33 offen offset:0 sc1 lds
    buffer_load_dwordx4 v32, s[24:27], s33 offen offset:1024 sc1 lds
    buffer_load_dwordx4 v32, s[24:27], s33 offen offset:2048 sc1 lds
    buffer_load_dwordx4 v32, s[24:27], s33 offen offset:3072 sc1 lds
    s_add_u32 s40, s40, 4096
    s_and_b32 s40, s40, 0x3fff
    s_mov_b32 m0, 106496
    s_add_u32 s33, s34, s40
    buffer_load_dwordx4 v32, s[24:27], s33 offen offset:0 sc1 lds
    buffer_load_dwordx4 v32, s[24:27], s33 offen offset:1024 sc1 lds
    buffer_load_dwordx4 v32, s[24:27], s33 offen offset:2048 sc1 lds
    buffer_load_dwordx4 v32, s[24:27], s33 offen offset:3072 sc1 lds
    s_add_u32 s40, s40, 4096
    s_and_b32 s40, s40, 0x3fff
    s_mov_b32 m0, 110592
    s_add_u32 s33, s34, s40
    buffer_load_dwordx4 v32, s[24:27], s33 offen offset:0 sc1 lds
    buffer_load_dwordx4 v32, s[24:27], s33 offen offset:1024 sc1 lds
    buffer_load_dwordx4 v32, s[24:27], s33 offen offset:2048 sc1 lds
    buffer_load_dwordx4 v32, s[24:27], s33 offen offset:3072 sc1 lds
    s_add_u32 s40, s40, 4096
    s_and_b32 s40, s40, 0x3fff
    s_add_u32 s41, s41, 1
    s_and_b32 s41, s41, 7
    s_waitcnt vmcnt(32)
    s_barrier
    s_lshl_b32 s34, s41, 2
    s_lshl_b32 s35, 0xf, s34
    s_andn2_b32 s34, s35, s44
    s_cbranch_scc0 L10
    s_call_b64 s[4:5], L_poll1
L10:
    s_lshl_b32 s34, s41, 17
    s_mov_b32 m0, 114688
    s_add_u32 s33, s34, s40
    buffer_load_dwordx4 v32, s[24:27], s33 offen offset:0 sc1 lds
    buffer_load_dwordx4 v32, s[24:27], s33 offen offset:1024 sc1 lds
    buffer_load_dwordx4 v32, s[24:27], s33 offen offset:2048 sc1 lds
    buffer_load_dwordx4 v32, s[24:27], s33 offen offset:3072 sc1 lds
    s_add_u32 s40, s40, 4096
    s_and_b32 s40, s40, 0x3fff
    s_mov_b32 m0, 118784
    s_add_u32 s33, s34, s40
    buffer_load_dwordx4 v32, s[24:27], s33 offen offset:0 sc1 lds
    buffer_load_dwordx4 v32, s[24:27], s33 offen offset:1024 sc1 lds
    buffer_load_dwordx4 v32, s[24:27], s33 offen offset:2048 sc1 lds
    buffer_load_dwordx4 v32, s[24:27], s33 offen offset:3072 sc1 lds
    s_add_u32 s40, s40, 4096
    s_and_b32 s40, s40, 0x3fff
    s_mov_b32 m0, 122880
    s_add_u32 s33, s34, s40
    buffer_load_dwordx4 v32, s[24:27], s33 offen offset:0 sc1 lds
    buffer_load_dwordx4 v32, s[24:27], s33 offen offset:1024 sc1 lds
    buffer_load_dwordx4 v32, s[24:27], s33 offen offset:2048 sc1 lds
    buffer_load_dwordx4 v32, s[24:27], s33 offen offset:3072 sc1 lds
    s_add_u32 s40, s40, 4096
    s_and_b32 s40, s40, 0x3fff
    s_mov_b32 m0, 126976
    s_add_u32 s33, s34, s40
    buffer_load_dwordx4 v32, s[24:27], s33 offen offset:0 sc1 lds
    buffer_load_dwordx4 v32, s[24:27], s33 offen offset:1024 sc1 lds
    buffer_load_dwordx4 v32, s[24:27], s33 offen offset:2048 sc1 lds
    buffer_load_dwordx4 v32, s[24:27], s33 offen offset:3072 sc1 lds
    s_add_u32 s40, s40, 4096
    s_and_b32 s40, s40, 0x3fff
    s_add_u32 s41, s41, 1
    s_and_b32 s41, s41, 7
    s_waitcnt vmcnt(32)
    s_barrier
    s_waitcnt vmcnt(16)
    s_barrier
    s_waitcnt vmcnt(0)
    s_barrier
    s_branch L_done
L_prod_notile:
    s_waitcnt vmcnt(0)
    s_barrier
    s_branch L_done
L_poll1:
    s_mov_b32 s37, 0
    s_mov_b32 s33, 16777216
L_poll1_loop:
    buffer_load_dword v39, v36, s[24:27], s33 offen sc1
    s_add_u32 s37, s37, 1
    s_waitcnt vmcnt(0)
    v_cmp_eq_u32 s[44:45], s3, v39
    s_cmp_gt_u32 s37, 400000
    s_cbranch_scc1 L_poll1_end
    s_andn2_b32 s34, s35, s44
    s_cbranch_scc1 L_poll1_loop
L_poll1_end:
    s_setpc_b64 s[4:5]
    .p2align 12
L_stubC:
    s_setpc_b64 s[4:5]
L_pgC:
L_notprod:
    s_waitcnt lgkmcnt(0)
    s_mov_b32 s24, s48
    s_and_b32 s25, s49, 0xffff
    s_mov_b32 s26, 18874368
    s_mov_b32 s27, 0x20000
    s_mov_b32 s52, s60
    s_and_b32 s53, s61, 0xffff
    s_mov_b32 s54, 256
    s_mov_b32 s55, 0x20000
    s_mov_b32 s56, s6
    s_and_b32 s57, s7, 0xffff
    s_mov_b32 s58, 983040
    s_mov_b32 s59, 0x20000
    s_lshl_b32 s33, s2, 3
    s_add_u32 s33, s33, s30
    s_cmp_lg_u32 s33, 5
    s_cbranch_scc1 L_nononce
    s_mov_b32 s33, 17301504
    buffer_load_dword v4, off, s[24:27], s33 sc1
    s_mov_b32 s34, 0x9e3779b1
    s_waitcnt vmcnt(0)
    v_mul_lo_u32 v4, v4, s34
    v_add_u32 v4, 0x7f4a7c15, v4
    v_max_u32 v4, 1, v4
    s_mov_b64 exec, 1
    buffer_store_dword v4, off, s[52:55], 0 sc1
    buffer_store_dword v4, off, s[24:27], s33 sc1
    s_mov_b64 exec, -1
L_nononce:
    s_cmp_gt_u32 s30, 4
    s_cselect_b32 s33, 1, 0
    s_sub_u32 s51, s30, s33
    s_lshl_b32 s33, s51, 12
    s_add_u32 s33, s33, 90112
    v_lshlrev_b32 v28, 4, v1
    v_add_u32 v25, s33, v28
    s_cmp_ge_u32 s51, 3
    s_cselect_b32 s35, 12288, 0
    v_lshrrev_b32 v4, 1, v2
    v_xor_b32 v4, v4, v3
    v_lshlrev_b32 v4, 4, v4
    v_lshl_add_u32 v4, v3, 8, v4
    v_and_b32 v5, 1, v2
    v_lshl_add_u32 v4, v5, 3, v4
    s_add_u32 s33, s35, 114688
    v_add_u32 v26, s33, v4
    v_lshrrev_b32 v4, 2, v3
    v_lshl_add_u32 v4, v2, 2, v4
    v_and_b32 v5, 7, v4
    v_lshlrev_b32 v5, 5, v5
    v_lshl_add_u32 v4, v4, 8, v5
    v_and_b32 v5, 3, v3
    v_lshl_add_u32 v30, v5, 3, v4
    s_add_u32 s33, s35, 139264
    v_add_u32 v27, s33, v30
    s_lshr_b32 s31, s30, 1
    s_and_b32 s32, s30, 1
    s_mul_i32 s33, s31, 12288
    s_lshl_b32 s34, s32, 11
    s_add_u32 s33, s33, s34
    s_add_u32 s33, s33, 90112
    v_add_u32 v24, s33, v28
    s_mul_i32 s33, s29, 6
    s_add_u32 s33, s33, s51
    s_lshl_b32 s33, s33, 7
    s_lshl_b32 s34, s28, 2
    s_add_u32 s33, s33, s34
    s_lshl_b32 s38, s33, 5
    s_add_u32 s38, s38, 16777216
    s_lshl_b32 s33, s33, 10
    v_add_u32 v28, s33, v28
    s_mov_b32 s50, 0x3e0293ee
    s_mov_b32 s51, 0x3e0293ee
    s_lshl_b32 s33, s29, 2
    s_lshr_b32 s39, 2252506690, s33
    s_and_b32 s39, s39, 0xf
    s_cmp_lt_u32 s30, 4
    s_cbranch_scc1 L_cons
    s_barrier
    s_call_b64 s[4:5], L_stubD
    s_call_b64 s[4:5], L_stubE
    s_call_b64 s[4:5], L_stubF
    s_call_b64 s[4:5], L_stubB
    s_barrier
    s_cmp_lg_u32 s39, 2
    s_cbranch_scc1 L11
    s_call_b64 s[4:5], L_kvread
L11:
    s_barrier
    s_barrier
    s_cmp_lg_u32 s39, 4
    s_cbranch_scc1 L12
    s_call_b64 s[4:5], L_kvread
L12:
    s_barrier
    s_barrier
    s_cmp_lg_u32 s39, 6
    s_cbranch_scc1 L13
    s_call_b64 s[4:5], L_kvread
L13:
    s_barrier
    s_load_dword s3, s[60:61], 0
    s_barrier
    s_cmp_lg_u32 s39, 8
    s_cbranch_scc1 L14
    s_call_b64 s[4:5], L_kvread
L14:
    s_barrier
    s_waitcnt lgkmcnt(0)
    s_barrier
    s_branch L_qx
L_kvread:
    s_barrier
    v_xor_b32 v4, 0, v26
    ds_read_b64 v[136:137], v4 offset:0
    ds_read_b64 v[152:153], v4 offset:4096
    ds_read_b64 v[168:169], v4 offset:8192
    v_xor_b32 v5, 32, v26
    ds_read_b64 v[138:139], v5 offset:0
    ds_read_b64 v[154:155], v5 offset:4096
    ds_read_b64 v[170:171], v5 offset:8192
    v_xor_b32 v6, 64, v26
    ds_read_b64 v[140:141], v6 offset:0
    ds_read_b64 v[156:157], v6 offset:4096
    ds_read_b64 v[172:173], v6 offset:8192
    v_xor_b32 v7, 96, v26
    ds_read_b64 v[142:143], v7 offset:0
    ds_read_b64 v[158:159], v7 offset:4096
    ds_read_b64 v[174:175], v7 offset:8192
    v_xor_b32 v4, 128, v26
    ds_read_b64 v[144:145], v4 offset:0
    ds_read_b64 v[160:161], v4 offset:4096
    ds_read_b64 v[176:177], v4 offset:8192
    v_xor_b32 v5, 160, v26
    ds_read_b64 v[146:147], v5 offset:0
    ds_read_b64 v[162:163], v5 offset:4096
    ds_read_b64 v[178:179], v5 offset:8192
    v_xor_b32 v6, 192, v26
    ds_read_b64 v[148:149], v6 offset:0
    ds_read_b64 v[164:165], v6 offset:4096
    ds_read_b64 v[180:181], v6 offset:8192
    v_xor_b32 v7, 224, v26
    ds_read_b64 v[150:151], v7 offset:0
    ds_read_b64 v[166:167], v7 offset:4096
    ds_read_b64 v[182:183], v7 offset:8192
    s_barrier
    v_xor_b32 v8, 0, v27
    ds_read_b64_tr_b16 v[184:185], v8 offset:0
    ds_read_b64_tr_b16 v[186:187], v8 offset:4096
    ds_read_b64_tr_b16 v[188:189], v8 offset:8192
    v_xor_b32 v9, 32, v27
    ds_read_b64_tr_b16 v[190:191], v9 offset:0
    ds_read_b64_tr_b16 v[192:193], v9 offset:4096
    ds_read_b64_tr_b16 v[194:195], v9 offset:8192
    v_xor_b32 v10, 64, v27
    ds_read_b64_tr_b16 v[196:197], v10 offset:0
    ds_read_b64_tr_b16 v[198:199], v10 offset:4096
    ds_read_b64_tr_b16 v[200:201], v10 offset:8192
    v_xor_b32 v11, 96, v27
    ds_read_b64_tr_b16 v[202:203], v11 offset:0
    ds_read_b64_tr_b16 v[204:205], v11 offset:4096
    ds_read_b64_tr_b16 v[206:207], v11 offset:8192
    v_xor_b32 v8, 128, v27
    ds_read_b64_tr_b16 v[208:209], v8 offset:0
    ds_read_b64_tr_b16 v[210:211], v8 offset:4096
    ds_read_b64_tr_b16 v[212:213], v8 offset:8192
    v_xor_b32 v9, 160, v27
    ds_read_b64_tr_b16 v[214:215], v9 offset:0
    ds_read_b64_tr_b16 v[216:217], v9 offset:4096
    ds_read_b64_tr_b16 v[218:219], v9 offset:8192
    v_xor_b32 v10, 192, v27
    ds_read_b64_tr_b16 v[220:221], v10 offset:0
    ds_read_b64_tr_b16 v[222:223], v10 offset:4096
    ds_read_b64_tr_b16 v[224:225], v10 offset:8192
    v_xor_b32 v11, 224, v27
    ds_read_b64_tr_b16 v[226:227], v11 offset:0
    ds_read_b64_tr_b16 v[228:229], v11 offset:4096
    ds_read_b64_tr_b16 v[230:231], v11 offset:8192
    s_setpc_b64 s[4:5]
L_cons:
    s_mul_i32 s33, s31, 6144
    v_and_b32 v4, 7, v3
    v_xor_b32 v4, v4, v2
    v_lshlrev_b32 v4, 4, v4
    v_lshl_add_u32 v4, v3, 7, v4
    v_add_u32 v12, s33, v4
    v_xor_b32 v14, 64, v12
    v_add_u32 v13, 57344, v12
    v_add_u32 v15, 57344, v14
    v_lshrrev_b32 v4, 2, v3
    v_lshl_add_u32 v5, v2, 3, v4
    v_lshlrev_b32 v5, 8, v5
    v_and_b32 v6, 1, v2
    v_lshlrev_b32 v6, 3, v6
    v_lshl_add_u32 v6, v4, 1, v6
    v_and_b32 v7, 3, v3
    v_lshlrev_b32 v7, 3, v7
    v_add_u32 v5, v5, v7
    v_add_u32 v5, 12288, v5
    s_lshl_b32 s33, s32, 3
    v_xor_b32 v6, s33, v6
    v_lshl_add_u32 v16, v6, 4, v5
    v_xor_b32 v18, 32, v16
    v_xor_b32 v20, 64, v16
    v_xor_b32 v22, 96, v16
    v_add_u32 v17, 57344, v16
    v_add_u32 v19, 57344, v18
    v_add_u32 v21, 57344, v20
    v_add_u32 v23, 57344, v22
    s_barrier
    ds_read_b128 v[96:99], v12 offset:0
    ds_read_b64_tr_b16 v[80:81], v16 offset:0
    ds_read_b64_tr_b16 v[82:83], v16 offset:1024
    ds_read_b64_tr_b16 v[84:85], v18 offset:0
    ds_read_b64_tr_b16 v[86:87], v18 offset:1024
    ds_read_b64_tr_b16 v[88:89], v20 offset:0
    ds_read_b64_tr_b16 v[90:91], v20 offset:1024
    ds_read_b64_tr_b16 v[92:93], v22 offset:0
    ds_read_b64_tr_b16 v[94:95], v22 offset:1024
    ds_read_b128 v[100:103], v12 offset:2048
    ds_read_b128 v[104:107], v12 offset:4096
    s_waitcnt lgkmcnt(0)
    ds_read_b128 v[124:127], v14 offset:0
    ds_read_b64_tr_b16 v[108:109], v16 offset:8192
    v_mfma_f32_16x16x32_bf16 v[32:35], v[80:83], v[96:99], 0
    ds_read_b64_tr_b16 v[110:111], v16 offset:9216
    ds_read_b64_tr_b16 v[112:113], v18 offset:8192
    v_mfma_f32_16x16x32_bf16 v[44:47], v[84:87], v[96:99], 0
    ds_read_b64_tr_b16 v[114:115], v18 offset:9216
    ds_read_b64_tr_b16 v[116:117], v20 offset:8192
    v_mfma_f32_16x16x32_bf16 v[56:59], v[88:91], v[96:99], 0
    ds_read_b64_tr_b16 v[118:119], v20 offset:9216
    ds_read_b64_tr_b16 v[120:121], v22 offset:8192
    v_mfma_f32_16x16x32_bf16 v[68:71], v[92:95], v[96:99], 0
    ds_read_b64_tr_b16 v[122:123], v22 offset:9216
    ds_read_b128 v[128:131], v14 offset:2048
    v_mfma_f32_16x16x32_bf16 v[36:39], v[80:83], v[100:103], 0
    ds_read_b128 v[132:135], v14 offset:4096
    v_mfma_f32_16x16x32_bf16 v[48:51], v[84:87], v[100:103], 0
    v_mfma_f32_16x16x32_bf16 v[60:63], v[88:91], v[100:103], 0
    v_mfma_f32_16x16x32_bf16 v[72:75], v[92:95], v[100:103], 0
    v_mfma_f32_16x16x32_bf16 v[40:43], v[80:83], v[104:107], 0
    v_mfma_f32_16x16x32_bf16 v[52:55], v[84:87], v[104:107], 0
    v_mfma_f32_16x16x32_bf16 v[64:67], v[88:91], v[104:107], 0
    v_mfma_f32_16x16x32_bf16 v[76:79], v[92:95], v[104:107], 0
    s_waitcnt lgkmcnt(0)
    s_barrier
    ds_read_b128 v[96:99], v12 offset:28672
    ds_read_b64_tr_b16 v[80:81], v16 offset:28672
    v_mfma_f32_16x16x32_bf16 v[32:35], v[108:111], v[124:127], v[32:35]
    ds_read_b64_tr_b16 v[82:83], v16 offset:29696
    ds_read_b64_tr_b16 v[84:85], v18 offset:28672
    v_mfma_f32_16x16x32_bf16 v[44:47], v[112:115], v[124:127], v[44:47]
    ds_read_b64_tr_b16 v[86:87], v18 offset:29696
    ds_read_b64_tr_b16 v[88:89], v20 offset:28672
    v_mfma_f32_16x16x32_bf16 v[56:59], v[116:119], v[124:127], v[56:59]
    ds_read_b64_tr_b16 v[90:91], v20 offset:29696
    ds_read_b64_tr_b16 v[92:93], v22 offset:28672
    v_mfma_f32_16x16x32_bf16 v[68:71], v[120:123], v[124:127], v[68:71]
    ds_read_b64_tr_b16 v[94:95], v22 offset:29696
    ds_read_b128 v[100:103], v12 offset:30720
    v_mfma_f32_16x16x32_bf16 v[36:39], v[108:111], v[128:131], v[36:39]
    ds_read_b128 v[104:107], v12 offset:32768
    v_mfma_f32_16x16x32_bf16 v[48:51], v[112:115], v[128:131], v[48:51]
    v_mfma_f32_16x16x32_bf16 v[60:63], v[116:119], v[128:131], v[60:63]
    v_mfma_f32_16x16x32_bf16 v[72:75], v[120:123], v[128:131], v[72:75]
    v_mfma_f32_16x16x32_bf16 v[40:43], v[108:111], v[132:135], v[40:43]
    v_mfma_f32_16x16x32_bf16 v[52:55], v[112:115], v[132:135], v[52:55]
    v_mfma_f32_16x16x32_bf16 v[64:67], v[116:119], v[132:135], v[64:67]
    v_mfma_f32_16x16x32_bf16 v[76:79], v[120:123], v[132:135], v[76:79]
    s_waitcnt lgkmcnt(0)
    ds_read_b128 v[124:127], v14 offset:28672
    ds_read_b64_tr_b16 v[108:109], v16 offset:36864
    v_mfma_f32_16x16x32_bf16 v[32:35], v[80:83], v[96:99], v[32:35]
    ds_read_b64_tr_b16 v[110:111], v16 offset:37888
    ds_read_b64_tr_b16 v[112:113], v18 offset:36864
    v_mfma_f32_16x16x32_bf16 v[44:47], v[84:87], v[96:99], v[44:47]
    ds_read_b64_tr_b16 v[114:115], v18 offset:37888
    ds_read_b64_tr_b16 v[116:117], v20 offset:36864
    v_mfma_f32_16x16x32_bf16 v[56:59], v[88:91], v[96:99], v[56:59]
    ds_read_b64_tr_b16 v[118:119], v20 offset:37888
    ds_read_b64_tr_b16 v[120:121], v22 offset:36864
    v_mfma_f32_16x16x32_bf16 v[68:71], v[92:95], v[96:99], v[68:71]
    ds_read_b64_tr_b16 v[122:123], v22 offset:37888
    ds_read_b128 v[128:131], v14 offset:30720
    v_mfma_f32_16x16x32_bf16 v[36:39], v[80:83], v[100:103], v[36:39]
    ds_read_b128 v[132:135], v14 offset:32768
    v_mfma_f32_16x16x32_bf16 v[48:51], v[84:87], v[100:103], v[48:51]
    v_mfma_f32_16x16x32_bf16 v[60:63], v[88:91], v[100:103], v[60:63]
    v_mfma_f32_16x16x32_bf16 v[72:75], v[92:95], v[100:103], v[72:75]
    v_mfma_f32_16x16x32_bf16 v[40:43], v[80:83], v[104:107], v[40:43]
    v_mfma_f32_16x16x32_bf16 v[52:55], v[84:87], v[104:107], v[52:55]
    v_mfma_f32_16x16x32_bf16 v[64:67], v[88:91], v[104:107], v[64:67]
    v_mfma_f32_16x16x32_bf16 v[76:79], v[92:95], v[104:107], v[76:79]
    s_waitcnt lgkmcnt(0)
    s_cmp_lg_u32 s39, 2
    s_cbranch_scc1 L15
    s_call_b64 s[4:5], L_kvread
L15:
    s_barrier
    ds_read_b128 v[96:99], v13 offset:0
    ds_read_b64_tr_b16 v[80:81], v17 offset:0
    v_mfma_f32_16x16x32_bf16 v[32:35], v[108:111], v[124:127], v[32:35]
    ds_read_b64_tr_b16 v[82:83], v17 offset:1024
    ds_read_b64_tr_b16 v[84:85], v19 offset:0
    v_mfma_f32_16x16x32_bf16 v[44:47], v[112:115], v[124:127], v[44:47]
    ds_read_b64_tr_b16 v[86:87], v19 offset:1024
    ds_read_b64_tr_b16 v[88:89], v21 offset:0
    v_mfma_f32_16x16x32_bf16 v[56:59], v[116:119], v[124:127], v[56:59]
    ds_read_b64_tr_b16 v[90:91], v21 offset:1024
    ds_read_b64_tr_b16 v[92:93], v23 offset:0
    v_mfma_f32_16x16x32_bf16 v[68:71], v[120:123], v[124:127], v[68:71]
    ds_read_b64_tr_b16 v[94:95], v23 offset:1024
    ds_read_b128 v[100:103], v13 offset:2048
    v_mfma_f32_16x16x32_bf16 v[36:39], v[108:111], v[128:131], v[36:39]
    ds_read_b128 v[104:107], v13 offset:4096
    v_mfma_f32_16x16x32_bf16 v[48:51], v[112:115], v[128:131], v[48:51]
    v_mfma_f32_16x16x32_bf16 v[60:63], v[116:119], v[128:131], v[60:63]
    v_mfma_f32_16x16x32_bf16 v[72:75], v[120:123], v[128:131], v[72:75]
    v_mfma_f32_16x16x32_bf16 v[40:43], v[108:111], v[132:135], v[40:43]
    v_mfma_f32_16x16x32_bf16 v[52:55], v[112:115], v[132:135], v[52:55]
    v_mfma_f32_16x16x32_bf16 v[64:67], v[116:119], v[132:135], v[64:67]
    v_mfma_f32_16x16x32_bf16 v[76:79], v[120:123], v[132:135], v[76:79]
    s_waitcnt lgkmcnt(0)
    ds_read_b128 v[124:127], v15 offset:0
    ds_read_b64_tr_b16 v[108:109], v17 offset:8192
    v_mfma_f32_16x16x32_bf16 v[32:35], v[80:83], v[96:99], v[32:35]
    ds_read_b64_tr_b16 v[110:111], v17 offset:9216
    ds_read_b64_tr_b16 v[112:113], v19 offset:8192
    v_mfma_f32_16x16x32_bf16 v[44:47], v[84:87], v[96:99], v[44:47]
    ds_read_b64_tr_b16 v[114:115], v19 offset:9216
    ds_read_b64_tr_b16 v[116:117], v21 offset:8192
    v_mfma_f32_16x16x32_bf16 v[56:59], v[88:91], v[96:99], v[56:59]
    ds_read_b64_tr_b16 v[118:119], v21 offset:9216
    ds_read_b64_tr_b16 v[120:121], v23 offset:8192
    v_mfma_f32_16x16x32_bf16 v[68:71], v[92:95], v[96:99], v[68:71]
    ds_read_b64_tr_b16 v[122:123], v23 offset:9216
    ds_read_b128 v[128:131], v15 offset:2048
    v_mfma_f32_16x16x32_bf16 v[36:39], v[80:83], v[100:103], v[36:39]
    ds_read_b128 v[132:135], v15 offset:4096
    v_mfma_f32_16x16x32_bf16 v[48:51], v[84:87], v[100:103], v[48:51]
    v_mfma_f32_16x16x32_bf16 v[60:63], v[88:91], v[100:103], v[60:63]
    v_mfma_f32_16x16x32_bf16 v[72:75], v[92:95], v[100:103], v[72:75]
    v_mfma_f32_16x16x32_bf16 v[40:43], v[80:83], v[104:107], v[40:43]
    v_mfma_f32_16x16x32_bf16 v[52:55], v[84:87], v[104:107], v[52:55]
    v_mfma_f32_16x16x32_bf16 v[64:67], v[88:91], v[104:107], v[64:67]
    v_mfma_f32_16x16x32_bf16 v[76:79], v[92:95], v[104:107], v[76:79]
    s_waitcnt lgkmcnt(0)
    s_barrier
    ds_read_b128 v[96:99], v13 offset:28672
    ds_read_b64_tr_b16 v[80:81], v17 offset:28672
    v_mfma_f32_16x16x32_bf16 v[32:35], v[108:111], v[124:127], v[32:35]
    ds_read_b64_tr_b16 v[82:83], v17 offset:29696
    ds_read_b64_tr_b16 v[84:85], v19 offset:28672
    v_mfma_f32_16x16x32_bf16 v[44:47], v[112:115], v[124:127], v[44:47]
    ds_read_b64_tr_b16 v[86:87], v19 offset:29696
    ds_read_b64_tr_b16 v[88:89], v21 offset:28672
    v_mfma_f32_16x16x32_bf16 v[56:59], v[116:119], v[124:127], v[56:59]
    ds_read_b64_tr_b16 v[90:91], v21 offset:29696
    ds_read_b64_tr_b16 v[92:93], v23 offset:28672
    v_mfma_f32_16x16x32_bf16 v[68:71], v[120:123], v[124:127], v[68:71]
    ds_read_b64_tr_b16 v[94:95], v23 offset:29696
    ds_read_b128 v[100:103], v13 offset:30720
    v_mfma_f32_16x16x32_bf16 v[36:39], v[108:111], v[128:131], v[36:39]
    ds_read_b128 v[104:107], v13 offset:32768
    v_mfma_f32_16x16x32_bf16 v[48:51], v[112:115], v[128:131], v[48:51]
    v_mfma_f32_16x16x32_bf16 v[60:63], v[116:119], v[128:131], v[60:63]
    v_mfma_f32_16x16x32_bf16 v[72:75], v[120:123], v[128:131], v[72:75]
    v_mfma_f32_16x16x32_bf16 v[40:43], v[108:111], v[132:135], v[40:43]
    v_mfma_f32_16x16x32_bf16 v[52:55], v[112:115], v[132:135], v[52:55]
    v_mfma_f32_16x16x32_bf16 v[64:67], v[116:119], v[132:135], v[64:67]
    v_mfma_f32_16x16x32_bf16 v[76:79], v[120:123], v[132:135], v[76:79]
    s_waitcnt lgkmcnt(0)
    ds_read_b128 v[124:127], v15 offset:28672
    ds_read_b64_tr_b16 v[108:109], v17 offset:36864
    v_mfma_f32_16x16x32_bf16 v[32:35], v[80:83], v[96:99], v[32:35]
    ds_read_b64_tr_b16 v[110:111], v17 offset:37888
    ds_read_b64_tr_b16 v[112:113], v19 offset:36864
    v_mfma_f32_16x16x32_bf16 v[44:47], v[84:87], v[96:99], v[44:47]
    ds_read_b64_tr_b16 v[114:115], v19 offset:37888
    ds_read_b64_tr_b16 v[116:117], v21 offset:36864
    v_mfma_f32_16x16x32_bf16 v[56:59], v[88:91], v[96:99], v[56:59]
    ds_read_b64_tr_b16 v[118:119], v21 offset:37888
    ds_read_b64_tr_b16 v[120:121], v23 offset:36864
    v_mfma_f32_16x16x32_bf16 v[68:71], v[92:95], v[96:99], v[68:71]
    ds_read_b64_tr_b16 v[122:123], v23 offset:37888
    ds_read_b128 v[128:131], v15 offset:30720
    v_mfma_f32_16x16x32_bf16 v[36:39], v[80:83], v[100:103], v[36:39]
    ds_read_b128 v[132:135], v15 offset:32768
    v_mfma_f32_16x16x32_bf16 v[48:51], v[84:87], v[100:103], v[48:51]
    v_mfma_f32_16x16x32_bf16 v[60:63], v[88:91], v[100:103], v[60:63]
    v_mfma_f32_16x16x32_bf16 v[72:75], v[92:95], v[100:103], v[72:75]
    v_mfma_f32_16x16x32_bf16 v[40:43], v[80:83], v[104:107], v[40:43]
    v_mfma_f32_16x16x32_bf16 v[52:55], v[84:87], v[104:107], v[52:55]
    v_mfma_f32_16x16x32_bf16 v[64:67], v[88:91], v[104:107], v[64:67]
    v_mfma_f32_16x16x32_bf16 v[76:79], v[92:95], v[104:107], v[76:79]
    s_waitcnt lgkmcnt(0)
    s_cmp_lg_u32 s39, 4
    s_cbranch_scc1 L16
    s_call_b64 s[4:5], L_kvread
L16:
    s_barrier
    ds_read_b128 v[96:99], v12 offset:0
    ds_read_b64_tr_b16 v[80:81], v16 offset:0
    v_mfma_f32_16x16x32_bf16 v[32:35], v[108:111], v[124:127], v[32:35]
    ds_read_b64_tr_b16 v[82:83], v16 offset:1024
    ds_read_b64_tr_b16 v[84:85], v18 offset:0
    v_mfma_f32_16x16x32_bf16 v[44:47], v[112:115], v[124:127], v[44:47]
    ds_read_b64_tr_b16 v[86:87], v18 offset:1024
    ds_read_b64_tr_b16 v[88:89], v20 offset:0
    v_mfma_f32_16x16x32_bf16 v[56:59], v[116:119], v[124:127], v[56:59]
    ds_read_b64_tr_b16 v[90:91], v20 offset:1024
    ds_read_b64_tr_b16 v[92:93], v22 offset:0
    v_mfma_f32_16x16x32_bf16 v[68:71], v[120:123], v[124:127], v[68:71]
    ds_read_b64_tr_b16 v[94:95], v22 offset:1024
    ds_read_b128 v[100:103], v12 offset:2048
    v_mfma_f32_16x16x32_bf16 v[36:39], v[108:111], v[128:131], v[36:39]
    ds_read_b128 v[104:107], v12 offset:4096
    v_mfma_f32_16x16x32_bf16 v[48:51], v[112:115], v[128:131], v[48:51]
    v_mfma_f32_16x16x32_bf16 v[60:63], v[116:119], v[128:131], v[60:63]
    v_mfma_f32_16x16x32_bf16 v[72:75], v[120:123], v[128:131], v[72:75]
    v_mfma_f32_16x16x32_bf16 v[40:43], v[108:111], v[132:135], v[40:43]
    v_mfma_f32_16x16x32_bf16 v[52:55], v[112:115], v[132:135], v[52:55]
    v_mfma_f32_16x16x32_bf16 v[64:67], v[116:119], v[132:135], v[64:67]
    v_mfma_f32_16x16x32_bf16 v[76:79], v[120:123], v[132:135], v[76:79]
    s_waitcnt lgkmcnt(0)
    ds_read_b128 v[124:127], v14 offset:0
    ds_read_b64_tr_b16 v[108:109], v16 offset:8192
    v_mfma_f32_16x16x32_bf16 v[32:35], v[80:83], v[96:99], v[32:35]
    ds_read_b64_tr_b16 v[110:111], v16 offset:9216
    ds_read_b64_tr_b16 v[112:113], v18 offset:8192
    v_mfma_f32_16x16x32_bf16 v[44:47], v[84:87], v[96:99], v[44:47]
    ds_read_b64_tr_b16 v[114:115], v18 offset:9216
    ds_read_b64_tr_b16 v[116:117], v20 offset:8192
    v_mfma_f32_16x16x32_bf16 v[56:59], v[88:91], v[96:99], v[56:59]
    ds_read_b64_tr_b16 v[118:119], v20 offset:9216
    ds_read_b64_tr_b16 v[120:121], v22 offset:8192
    v_mfma_f32_16x16x32_bf16 v[68:71], v[92:95], v[96:99], v[68:71]
    ds_read_b64_tr_b16 v[122:123], v22 offset:9216
    ds_read_b128 v[128:131], v14 offset:2048
    v_mfma_f32_16x16x32_bf16 v[36:39], v[80:83], v[100:103], v[36:39]
    ds_read_b128 v[132:135], v14 offset:4096
    v_mfma_f32_16x16x32_bf16 v[48:51], v[84:87], v[100:103], v[48:51]
    v_mfma_f32_16x16x32_bf16 v[60:63], v[88:91], v[100:103], v[60:63]
    v_mfma_f32_16x16x32_bf16 v[72:75], v[92:95], v[100:103], v[72:75]
    v_mfma_f32_16x16x32_bf16 v[40:43], v[80:83], v[104:107], v[40:43]
    v_mfma_f32_16x16x32_bf16 v[52:55], v[84:87], v[104:107], v[52:55]
    v_mfma_f32_16x16x32_bf16 v[64:67], v[88:91], v[104:107], v[64:67]
    v_mfma_f32_16x16x32_bf16 v[76:79], v[92:95], v[104:107], v[76:79]
    s_waitcnt lgkmcnt(0)
    s_barrier
    ds_read_b128 v[96:99], v12 offset:28672
    ds_read_b64_tr_b16 v[80:81], v16 offset:28672
    v_mfma_f32_16x16x32_bf16 v[32:35], v[108:111], v[124:127], v[32:35]
    ds_read_b64_tr_b16 v[82:83], v16 offset:29696
    ds_read_b64_tr_b16 v[84:85], v18 offset:28672
    v_mfma_f32_16x16x32_bf16 v[44:47], v[112:115], v[124:127], v[44:47]
    ds_read_b64_tr_b16 v[86:87], v18 offset:29696
    ds_read_b64_tr_b16 v[88:89], v20 offset:28672
    v_mfma_f32_16x16x32_bf16 v[56:59], v[116:119], v[124:127], v[56:59]
    ds_read_b64_tr_b16 v[90:91], v20 offset:29696
    ds_read_b64_tr_b16 v[92:93], v22 offset:28672
    v_mfma_f32_16x16x32_bf16 v[68:71], v[120:123], v[124:127], v[68:71]
    ds_read_b64_tr_b16 v[94:95], v22 offset:29696
    ds_read_b128 v[100:103], v12 offset:30720
    v_mfma_f32_16x16x32_bf16 v[36:39], v[108:111], v[128:131], v[36:39]
    ds_read_b128 v[104:107], v12 offset:32768
    v_mfma_f32_16x16x32_bf16 v[48:51], v[112:115], v[128:131], v[48:51]
    v_mfma_f32_16x16x32_bf16 v[60:63], v[116:119], v[128:131], v[60:63]
    v_mfma_f32_16x16x32_bf16 v[72:75], v[120:123], v[128:131], v[72:75]
    v_mfma_f32_16x16x32_bf16 v[40:43], v[108:111], v[132:135], v[40:43]
    v_mfma_f32_16x16x32_bf16 v[52:55], v[112:115], v[132:135], v[52:55]
    v_mfma_f32_16x16x32_bf16 v[64:67], v[116:119], v[132:135], v[64:67]
    v_mfma_f32_16x16x32_bf16 v[76:79], v[120:123], v[132:135], v[76:79]
    s_waitcnt lgkmcnt(0)
    ds_read_b128 v[124:127], v14 offset:28672
    ds_read_b64_tr_b16 v[108:109], v16 offset:36864
    v_mfma_f32_16x16x32_bf16 v[32:35], v[80:83], v[96:99], v[32:35]
    ds_read_b64_tr_b16 v[110:111], v16 offset:37888
    ds_read_b64_tr_b16 v[112:113], v18 offset:36864
    v_mfma_f32_16x16x32_bf16 v[44:47], v[84:87], v[96:99], v[44:47]
    ds_read_b64_tr_b16 v[114:115], v18 offset:37888
    ds_read_b64_tr_b16 v[116:117], v20 offset:36864
    v_mfma_f32_16x16x32_bf16 v[56:59], v[88:91], v[96:99], v[56:59]
    ds_read_b64_tr_b16 v[118:119], v20 offset:37888
    ds_read_b64_tr_b16 v[120:121], v22 offset:36864
    v_mfma_f32_16x16x32_bf16 v[68:71], v[92:95], v[96:99], v[68:71]
    ds_read_b64_tr_b16 v[122:123], v22 offset:37888
    ds_read_b128 v[128:131], v14 offset:30720
    v_mfma_f32_16x16x32_bf16 v[36:39], v[80:83], v[100:103], v[36:39]
    ds_read_b128 v[132:135], v14 offset:32768
    v_mfma_f32_16x16x32_bf16 v[48:51], v[84:87], v[100:103], v[48:51]
    v_mfma_f32_16x16x32_bf16 v[60:63], v[88:91], v[100:103], v[60:63]
    v_mfma_f32_16x16x32_bf16 v[72:75], v[92:95], v[100:103], v[72:75]
    v_mfma_f32_16x16x32_bf16 v[40:43], v[80:83], v[104:107], v[40:43]
    v_mfma_f32_16x16x32_bf16 v[52:55], v[84:87], v[104:107], v[52:55]
    v_mfma_f32_16x16x32_bf16 v[64:67], v[88:91], v[104:107], v[64:67]
    v_mfma_f32_16x16x32_bf16 v[76:79], v[92:95], v[104:107], v[76:79]
    s_waitcnt lgkmcnt(0)
    s_branch L_pgD
    .p2align 12
L_stubD:
    s_setpc_b64 s[4:5]
L_pgD:
    s_cmp_lg_u32 s39, 6
    s_cbranch_scc1 L17
    s_call_b64 s[4:5], L_kvread
L17:
    s_barrier
    s_load_dword s3, s[60:61], 0
    ds_read_b128 v[96:99], v13 offset:0
    ds_read_b64_tr_b16 v[80:81], v17 offset:0
    v_mfma_f32_16x16x32_bf16 v[32:35], v[108:111], v[124:127], v[32:35]
    ds_read_b64_tr_b16 v[82:83], v17 offset:1024
    ds_read_b64_tr_b16 v[84:85], v19 offset:0
    v_mfma_f32_16x16x32_bf16 v[44:47], v[112:115], v[124:127], v[44:47]
    ds_read_b64_tr_b16 v[86:87], v19 offset:1024
    ds_read_b64_tr_b16 v[88:89], v21 offset:0
    v_mfma_f32_16x16x32_bf16 v[56:59], v[116:119], v[124:127], v[56:59]
    ds_read_b64_tr_b16 v[90:91], v21 offset:1024
    ds_read_b64_tr_b16 v[92:93], v23 offset:0
    v_mfma_f32_16x16x32_bf16 v[68:71], v[120:123], v[124:127], v[68:71]
    ds_read_b64_tr_b16 v[94:95], v23 offset:1024
    ds_read_b128 v[100:103], v13 offset:2048
    v_mfma_f32_16x16x32_bf16 v[36:39], v[108:111], v[128:131], v[36:39]
    ds_read_b128 v[104:107], v13 offset:4096
    v_mfma_f32_16x16x32_bf16 v[48:51], v[112:115], v[128:131], v[48:51]
    v_mfma_f32_16x16x32_bf16 v[60:63], v[116:119], v[128:131], v[60:63]
    v_mfma_f32_16x16x32_bf16 v[72:75], v[120:123], v[128:131], v[72:75]
    v_mfma_f32_16x16x32_bf16 v[40:43], v[108:111], v[132:135], v[40:43]
    v_mfma_f32_16x16x32_bf16 v[52:55], v[112:115], v[132:135], v[52:55]
    v_mfma_f32_16x16x32_bf16 v[64:67], v[116:119], v[132:135], v[64:67]
    v_mfma_f32_16x16x32_bf16 v[76:79], v[120:123], v[132:135], v[76:79]
    s_waitcnt lgkmcnt(0)
    ds_read_b128 v[124:127], v15 offset:0
    ds_read_b64_tr_b16 v[108:109], v17 offset:8192
    v_mfma_f32_16x16x32_bf16 v[32:35], v[80:83], v[96:99], v[32:35]
    ds_read_b64_tr_b16 v[110:111], v17 offset:9216
    ds_read_b64_tr_b16 v[112:113], v19 offset:8192
    v_mfma_f32_16x16x32_bf16 v[44:47], v[84:87], v[96:99], v[44:47]
    ds_read_b64_tr_b16 v[114:115], v19 offset:9216
    ds_read_b64_tr_b16 v[116:117], v21 offset:8192
    v_mfma_f32_16x16x32_bf16 v[56:59], v[88:91], v[96:99], v[56:59]
    ds_read_b64_tr_b16 v[118:119], v21 offset:9216
    ds_read_b64_tr_b16 v[120:121], v23 offset:8192
    v_mfma_f32_16x16x32_bf16 v[68:71], v[92:95], v[96:99], v[68:71]
    ds_read_b64_tr_b16 v[122:123], v23 offset:9216
    ds_read_b128 v[128:131], v15 offset:2048
    v_mfma_f32_16x16x32_bf16 v[36:39], v[80:83], v[100:103], v[36:39]
    ds_read_b128 v[132:135], v15 offset:4096
    v_mfma_f32_16x16x32_bf16 v[48:51], v[84:87], v[100:103], v[48:51]
    v_mfma_f32_16x16x32_bf16 v[60:63], v[88:91], v[100:103], v[60:63]
    v_mfma_f32_16x16x32_bf16 v[72:75], v[92:95], v[100:103], v[72:75]
    v_mfma_f32_16x16x32_bf16 v[40:43], v[80:83], v[104:107], v[40:43]
    v_mfma_f32_16x16x32_bf16 v[52:55], v[84:87], v[104:107], v[52:55]
    v_mfma_f32_16x16x32_bf16 v[64:67], v[88:91], v[104:107], v[64:67]
    v_mfma_f32_16x16x32_bf16 v[76:79], v[92:95], v[104:107], v[76:79]
    s_waitcnt lgkmcnt(0)
    s_barrier
    ds_read_b128 v[96:99], v13 offset:28672
    ds_read_b64_tr_b16 v[80:81], v17 offset:28672
    v_mfma_f32_16x16x32_bf16 v[32:35], v[108:111], v[124:127], v[32:35]
    ds_read_b64_tr_b16 v[82:83], v17 offset:29696
    ds_read_b64_tr_b16 v[84:85], v19 offset:28672
    v_mfma_f32_16x16x32_bf16 v[44:47], v[112:115], v[124:127], v[44:47]
    ds_read_b64_tr_b16 v[86:87], v19 offset:29696
    ds_read_b64_tr_b16 v[88:89], v21 offset:28672
    v_mfma_f32_16x16x32_bf16 v[56:59], v[116:119], v[124:127], v[56:59]
    ds_read_b64_tr_b16 v[90:91], v21 offset:29696
    ds_read_b64_tr_b16 v[92:93], v23 offset:28672
    v_mfma_f32_16x16x32_bf16 v[68:71], v[120:123], v[124:127], v[68:71]
    ds_read_b64_tr_b16 v[94:95], v23 offset:29696
    ds_read_b128 v[100:103], v13 offset:30720
    v_mfma_f32_16x16x32_bf16 v[36:39], v[108:111], v[128:131], v[36:39]
    ds_read_b128 v[104:107], v13 offset:32768
    v_mfma_f32_16x16x32_bf16 v[48:51], v[112:115], v[128:131], v[48:51]
    v_mfma_f32_16x16x32_bf16 v[60:63], v[116:119], v[128:131], v[60:63]
    v_mfma_f32_16x16x32_bf16 v[72:75], v[120:123], v[128:131], v[72:75]
    v_mfma_f32_16x16x32_bf16 v[40:43], v[108:111], v[132:135], v[40:43]
    v_mfma_f32_16x16x32_bf16 v[52:55], v[112:115], v[132:135], v[52:55]
    v_mfma_f32_16x16x32_bf16 v[64:67], v[116:119], v[132:135], v[64:67]
    v_mfma_f32_16x16x32_bf16 v[76:79], v[120:123], v[132:135], v[76:79]
    s_waitcnt lgkmcnt(0)
    ds_read_b128 v[124:127], v15 offset:28672
    ds_read_b64_tr_b16 v[108:109], v17 offset:36864
    v_mfma_f32_16x16x32_bf16 v[32:35], v[80:83], v[96:99], v[32:35]
    ds_read_b64_tr_b16 v[110:111], v17 offset:37888
    ds_read_b64_tr_b16 v[112:113], v19 offset:36864
    v_mfma_f32_16x16x32_bf16 v[44:47], v[84:87], v[96:99], v[44:47]
    ds_read_b64_tr_b16 v[114:115], v19 offset:37888
    ds_read_b64_tr_b16 v[116:117], v21 offset:36864
    v_mfma_f32_16x16x32_bf16 v[56:59], v[88:91], v[96:99], v[56:59]
    ds_read_b64_tr_b16 v[118:119], v21 offset:37888
    ds_read_b64_tr_b16 v[120:121], v23 offset:36864
    v_mfma_f32_16x16x32_bf16 v[68:71], v[92:95], v[96:99], v[68:71]
    ds_read_b64_tr_b16 v[122:123], v23 offset:37888
    ds_read_b128 v[128:131], v15 offset:30720
    v_mfma_f32_16x16x32_bf16 v[36:39], v[80:83], v[100:103], v[36:39]
    ds_read_b128 v[132:135], v15 offset:32768
    v_mfma_f32_16x16x32_bf16 v[48:51], v[84:87], v[100:103], v[48:51]
    v_mfma_f32_16x16x32_bf16 v[60:63], v[88:91], v[100:103], v[60:63]
    v_mfma_f32_16x16x32_bf16 v[72:75], v[92:95], v[100:103], v[72:75]
    v_mfma_f32_16x16x32_bf16 v[40:43], v[80:83], v[104:107], v[40:43]
    v_mfma_f32_16x16x32_bf16 v[52:55], v[84:87], v[104:107], v[52:55]
    v_mfma_f32_16x16x32_bf16 v[64:67], v[88:91], v[104:107], v[64:67]
    v_mfma_f32_16x16x32_bf16 v[76:79], v[92:95], v[104:107], v[76:79]
    s_waitcnt lgkmcnt(0)
    s_cmp_lg_u32 s39, 8
    s_cbranch_scc1 L18
    s_call_b64 s[4:5], L_kvread
L18:
    s_barrier
    ds_read_b128 v[96:99], v12 offset:0
    ds_read_b64_tr_b16 v[80:81], v16 offset:0
    v_mfma_f32_16x16x32_bf16 v[32:35], v[108:111], v[124:127], v[32:35]
    ds_read_b64_tr_b16 v[82:83], v16 offset:1024
    ds_read_b64_tr_b16 v[84:85], v18 offset:0
    v_mfma_f32_16x16x32_bf16 v[44:47], v[112:115], v[124:127], v[44:47]
    ds_read_b64_tr_b16 v[86:87], v18 offset:1024
    ds_read_b64_tr_b16 v[88:89], v20 offset:0
    v_mfma_f32_16x16x32_bf16 v[56:59], v[116:119], v[124:127], v[56:59]
    ds_read_b64_tr_b16 v[90:91], v20 offset:1024
    ds_read_b64_tr_b16 v[92:93], v22 offset:0
    v_mfma_f32_16x16x32_bf16 v[68:71], v[120:123], v[124:127], v[68:71]
    ds_read_b64_tr_b16 v[94:95], v22 offset:1024
    ds_read_b128 v[100:103], v12 offset:2048
    v_mfma_f32_16x16x32_bf16 v[36:39], v[108:111], v[128:131], v[36:39]
    ds_read_b128 v[104:107], v12 offset:4096
    v_mfma_f32_16x16x32_bf16 v[48:51], v[112:115], v[128:131], v[48:51]
    v_mfma_f32_16x16x32_bf16 v[60:63], v[116:119], v[128:131], v[60:63]
    v_mfma_f32_16x16x32_bf16 v[72:75], v[120:123], v[128:131], v[72:75]
    v_mfma_f32_16x16x32_bf16 v[40:43], v[108:111], v[132:135], v[40:43]
    v_mfma_f32_16x16x32_bf16 v[52:55], v[112:115], v[132:135], v[52:55]
    v_mfma_f32_16x16x32_bf16 v[64:67], v[116:119], v[132:135], v[64:67]
    v_mfma_f32_16x16x32_bf16 v[76:79], v[120:123], v[132:135], v[76:79]
    s_waitcnt lgkmcnt(0)
    ds_read_b128 v[124:127], v14 offset:0
    ds_read_b64_tr_b16 v[108:109], v16 offset:8192
    v_mfma_f32_16x16x32_bf16 v[32:35], v[80:83], v[96:99], v[32:35]
    ds_read_b64_tr_b16 v[110:111], v16 offset:9216
    ds_read_b64_tr_b16 v[112:113], v18 offset:8192
    v_mfma_f32_16x16x32_bf16 v[44:47], v[84:87], v[96:99], v[44:47]
    ds_read_b64_tr_b16 v[114:115], v18 offset:9216
    ds_read_b64_tr_b16 v[116:117], v20 offset:8192
    v_mfma_f32_16x16x32_bf16 v[56:59], v[88:91], v[96:99], v[56:59]
    ds_read_b64_tr_b16 v[118:119], v20 offset:9216
    ds_read_b64_tr_b16 v[120:121], v22 offset:8192
    v_mfma_f32_16x16x32_bf16 v[68:71], v[92:95], v[96:99], v[68:71]
    ds_read_b64_tr_b16 v[122:123], v22 offset:9216
    ds_read_b128 v[128:131], v14 offset:2048
    v_mfma_f32_16x16x32_bf16 v[36:39], v[80:83], v[100:103], v[36:39]
    ds_read_b128 v[132:135], v14 offset:4096
    v_mfma_f32_16x16x32_bf16 v[48:51], v[84:87], v[100:103], v[48:51]
    v_mfma_f32_16x16x32_bf16 v[60:63], v[88:91], v[100:103], v[60:63]
    v_mfma_f32_16x16x32_bf16 v[72:75], v[92:95], v[100:103], v[72:75]
    v_mfma_f32_16x16x32_bf16 v[40:43], v[80:83], v[104:107], v[40:43]
    v_mfma_f32_16x16x32_bf16 v[52:55], v[84:87], v[104:107], v[52:55]
    v_mfma_f32_16x16x32_bf16 v[64:67], v[88:91], v[104:107], v[64:67]
    v_mfma_f32_16x16x32_bf16 v[76:79], v[92:95], v[104:107], v[76:79]
    s_waitcnt lgkmcnt(0)
    v_mfma_f32_16x16x32_bf16 v[32:35], v[108:111], v[124:127], v[32:35]
    v_mfma_f32_16x16x32_bf16 v[44:47], v[112:115], v[124:127], v[44:47]
    v_mfma_f32_16x16x32_bf16 v[56:59], v[116:119], v[124:127], v[56:59]
    v_mfma_f32_16x16x32_bf16 v[68:71], v[120:123], v[124:127], v[68:71]
    v_mfma_f32_16x16x32_bf16 v[36:39], v[108:111], v[128:131], v[36:39]
    v_mfma_f32_16x16x32_bf16 v[48:51], v[112:115], v[128:131], v[48:51]
    v_mfma_f32_16x16x32_bf16 v[60:63], v[116:119], v[128:131], v[60:63]
    v_mfma_f32_16x16x32_bf16 v[72:75], v[120:123], v[128:131], v[72:75]
    v_mfma_f32_16x16x32_bf16 v[40:43], v[108:111], v[132:135], v[40:43]
    v_mfma_f32_16x16x32_bf16 v[52:55], v[112:115], v[132:135], v[52:55]
    v_mfma_f32_16x16x32_bf16 v[64:67], v[116:119], v[132:135], v[64:67]
    v_mfma_f32_16x16x32_bf16 v[76:79], v[120:123], v[132:135], v[76:79]
    s_barrier
    ds_read_b128 v[96:99], v12 offset:28672
    ds_read_b64_tr_b16 v[80:81], v16 offset:28672
    ds_read_b64_tr_b16 v[82:83], v16 offset:29696
    ds_read_b64_tr_b16 v[84:85], v18 offset:28672
    ds_read_b64_tr_b16 v[86:87], v18 offset:29696
    ds_read_b64_tr_b16 v[88:89], v20 offset:28672
    ds_read_b64_tr_b16 v[90:91], v20 offset:29696
    ds_read_b64_tr_b16 v[92:93], v22 offset:28672
    ds_read_b64_tr_b16 v[94:95], v22 offset:29696
    ds_read_b128 v[124:127], v14 offset:28672
    ds_read_b64_tr_b16 v[108:109], v16 offset:36864
    ds_read_b64_tr_b16 v[110:111], v16 offset:37888
    ds_read_b64_tr_b16 v[112:113], v18 offset:36864
    ds_read_b64_tr_b16 v[114:115], v18 offset:37888
    ds_read_b64_tr_b16 v[116:117], v20 offset:36864
    s_waitcnt lgkmcnt(6)
    v_mfma_f32_16x16x32_bf16 v[32:35], v[80:83], v[96:99], v[32:35]
    ds_read_b64_tr_b16 v[118:119], v20 offset:37888
    ds_read_b64_tr_b16 v[120:121], v22 offset:36864
    v_mfma_f32_16x16x32_bf16 v[44:47], v[84:87], v[96:99], v[44:47]
    ds_read_b64_tr_b16 v[122:123], v22 offset:37888
    ds_read_b128 v[100:103], v12 offset:30720
    v_mfma_f32_16x16x32_bf16 v[56:59], v[88:91], v[96:99], v[56:59]
    ds_read_b128 v[128:131], v14 offset:30720
    ds_read_b128 v[104:107], v12 offset:32768
    v_mfma_f32_16x16x32_bf16 v[68:71], v[92:95], v[96:99], v[68:71]
    ds_read_b128 v[132:135], v14 offset:32768
    s_waitcnt lgkmcnt(4)
    v_mfma_f32_16x16x32_bf16 v[32:35], v[108:111], v[124:127], v[32:35]
    v_mfma_f32_16x16x32_bf16 v[44:47], v[112:115], v[124:127], v[44:47]
    v_mfma_f32_16x16x32_bf16 v[56:59], v[116:119], v[124:127], v[56:59]
    v_mfma_f32_16x16x32_bf16 v[68:71], v[120:123], v[124:127], v[68:71]
    s_waitcnt lgkmcnt(2)
    v_mfma_f32_16x16x32_bf16 v[36:39], v[80:83], v[100:103], v[36:39]
    v_mfma_f32_16x16x32_bf16 v[48:51], v[84:87], v[100:103], v[48:51]
    v_mfma_f32_16x16x32_bf16 v[60:63], v[88:91], v[100:103], v[60:63]
    v_mfma_f32_16x16x32_bf16 v[72:75], v[92:95], v[100:103], v[72:75]
    v_mfma_f32_16x16x32_bf16 v[36:39], v[108:111], v[128:131], v[36:39]
    v_mfma_f32_16x16x32_bf16 v[48:51], v[112:115], v[128:131], v[48:51]
    v_mfma_f32_16x16x32_bf16 v[60:63], v[116:119], v[128:131], v[60:63]
    s_waitcnt lgkmcnt(0)
    v_mfma_f32_16x16x32_bf16 v[72:75], v[120:123], v[128:131], v[72:75]
    v_cvt_pk_bf16_f32 v232, v32, v33
    v_cvt_pk_bf16_f32 v233, v34, v35
    v_mfma_f32_16x16x32_bf16 v[40:43], v[80:83], v[104:107], v[40:43]
    v_cvt_pk_bf16_f32 v234, v44, v45
    v_cvt_pk_bf16_f32 v235, v46, v47
    v_mfma_f32_16x16x32_bf16 v[52:55], v[84:87], v[104:107], v[52:55]
    ds_write_b128 v24, v[232:235] offset:0
    v_cvt_pk_bf16_f32 v236, v56, v57
    v_mfma_f32_16x16x32_bf16 v[64:67], v[88:91], v[104:107], v[64:67]
    v_cvt_pk_bf16_f32 v237, v58, v59
    v_cvt_pk_bf16_f32 v238, v68, v69
    v_mfma_f32_16x16x32_bf16 v[76:79], v[92:95], v[104:107], v[76:79]
    v_cvt_pk_bf16_f32 v239, v70, v71
    ds_write_b128 v24, v[236:239] offset:1024
    v_cvt_pk_bf16_f32 v240, v36, v37
    v_cvt_pk_bf16_f32 v241, v38, v39
    v_mfma_f32_16x16x32_bf16 v[40:43], v[108:111], v[132:135], v[40:43]
    v_cvt_pk_bf16_f32 v242, v48, v49
    v_cvt_pk_bf16_f32 v243, v50, v51
    v_mfma_f32_16x16x32_bf16 v[52:55], v[112:115], v[132:135], v[52:55]
    ds_write_b128 v24, v[240:243] offset:4096
    v_cvt_pk_bf16_f32 v244, v60, v61
    v_mfma_f32_16x16x32_bf16 v[64:67], v[116:119], v[132:135], v[64:67]
    v_mfma_f32_16x16x32_bf16 v[76:79], v[120:123], v[132:135], v[76:79]
    v_cvt_pk_bf16_f32 v245, v62, v63
    v_cvt_pk_bf16_f32 v246, v72, v73
    v_cvt_pk_bf16_f32 v247, v74, v75
    ds_write_b128 v24, v[244:247] offset:5120
    s_nop 3
    v_cvt_pk_bf16_f32 v248, v40, v41
    v_cvt_pk_bf16_f32 v249, v42, v43
    v_cvt_pk_bf16_f32 v250, v52, v53
    v_cvt_pk_bf16_f32 v251, v54, v55
    ds_write_b128 v24, v[248:251] offset:8192
    v_cvt_pk_bf16_f32 v252, v64, v65
    v_cvt_pk_bf16_f32 v253, v66, v67
    v_cvt_pk_bf16_f32 v254, v76, v77
    v_cvt_pk_bf16_f32 v255, v78, v79
    ds_write_b128 v24, v[252:255] offset:9216
L_qx:
    s_waitcnt lgkmcnt(0)
    s_barrier
    ds_read_b128 v[56:59], v25 offset:0
    ds_read_b128 v[60:63], v25 offset:1024
    ds_read_b128 v[64:67], v25 offset:2048
    ds_read_b128 v[68:71], v25 offset:3072
    s_waitcnt lgkmcnt(3)
    v_mfma_f32_16x16x32_bf16 v[32:35], v[136:139], v[56:59], 0
    v_mfma_f32_16x16x32_bf16 v[36:39], v[152:155], v[56:59], 0
    v_mfma_f32_16x16x32_bf16 v[40:43], v[168:171], v[56:59], 0
    s_waitcnt lgkmcnt(2)
    v_mfma_f32_16x16x32_bf16 v[32:35], v[140:143], v[60:63], v[32:35]
    v_mfma_f32_16x16x32_bf16 v[36:39], v[156:159], v[60:63], v[36:39]
    v_mfma_f32_16x16x32_bf16 v[40:43], v[172:175], v[60:63], v[40:43]
    s_waitcnt lgkmcnt(1)
    v_mfma_f32_16x16x32_bf16 v[32:35], v[144:147], v[64:67], v[32:35]
    v_mfma_f32_16x16x32_bf16 v[36:39], v[160:163], v[64:67], v[36:39]
    v_mfma_f32_16x16x32_bf16 v[40:43], v[176:179], v[64:67], v[40:43]
    s_waitcnt lgkmcnt(0)
    v_mfma_f32_16x16x32_bf16 v[32:35], v[148:151], v[68:71], v[32:35]
    v_mfma_f32_16x16x32_bf16 v[36:39], v[164:167], v[68:71], v[36:39]
    v_mfma_f32_16x16x32_bf16 v[40:43], v[180:183], v[68:71], v[40:43]
    s_nop 2
    s_nop 2
    v_max3_f32 v4, v32, v33, v34
    v_max3_f32 v5, v35, v36, v37
    v_max3_f32 v6, v38, v39, v40
    v_max3_f32 v7, v41, v42, v43
    v_max3_f32 v4, v4, v5, v6
    v_max_f32 v4, v4, v7
    v_mov_b32 v5, v4
    s_nop 1
    v_permlane32_swap_b32 v4, v5
    v_max_f32 v4, v4, v5
    v_mov_b32 v5, v4
    s_nop 1
    v_permlane16_swap_b32 v4, v5
    v_max_f32 v4, v4, v5
    v_mul_f32 v4, s50, v4
    v_pk_fma_f32 v[32:33], v[32:33], s[50:51], v[4:5] op_sel_hi:[1,1,0] neg_lo:[0,0,1] neg_hi:[0,0,1]
    v_pk_fma_f32 v[34:35], v[34:35], s[50:51], v[4:5] op_sel_hi:[1,1,0] neg_lo:[0,0,1] neg_hi:[0,0,1]
    v_pk_fma_f32 v[36:37], v[36:37], s[50:51], v[4:5] op_sel_hi:[1,1,0] neg_lo:[0,0,1] neg_hi:[0,0,1]
    v_pk_fma_f32 v[38:39], v[38:39], s[50:51], v[4:5] op_sel_hi:[1,1,0] neg_lo:[0,0,1] neg_hi:[0,0,1]
    v_pk_fma_f32 v[40:41], v[40:41], s[50:51], v[4:5] op_sel_hi:[1,1,0] neg_lo:[0,0,1] neg_hi:[0,0,1]
    v_pk_fma_f32 v[42:43], v[42:43], s[50:51], v[4:5] op_sel_hi:[1,1,0] neg_lo:[0,0,1] neg_hi:[0,0,1]
    v_exp_f32 v32, v32
    v_exp_f32 v33, v33
    v_exp_f32 v34, v34
    v_exp_f32 v35, v35
    v_exp_f32 v36, v36
    v_exp_f32 v37, v37
    v_exp_f32 v38, v38
    v_exp_f32 v39, v39
    v_exp_f32 v40, v40
    v_exp_f32 v41, v41
    v_exp_f32 v42, v42
    v_exp_f32 v43, v43
    s_waitcnt lgkmcnt(0)
    v_cvt_pk_bf16_f32 v44, v32, v33
    v_cvt_pk_bf16_f32 v45, v34, v35
    v_cvt_pk_bf16_f32 v46, v36, v37
    v_cvt_pk_bf16_f32 v47, v38, v39
    v_cvt_pk_bf16_f32 v48, v40, v41
    v_cvt_pk_bf16_f32 v49, v42, v43
    v_pk_add_f32 v[6:7], v[32:33], v[34:35]
    v_pk_add_f32 v[4:5], v[36:37], v[38:39]
    v_pk_add_f32 v[6:7], v[6:7], v[40:41]
    v_mfma_f32_16x16x32_bf16 v[80:83], v[184:187], v[44:47], 0
    v_pk_add_f32 v[4:5], v[4:5], v[42:43]
    v_pk_add_f32 v[6:7], v[6:7], v[4:5]
    v_mfma_f32_16x16x32_bf16 v[84:87], v[190:193], v[44:47], 0
    v_add_f32 v6, v6, v7
    v_mov_b32 v7, v6
    v_mfma_f32_16x16x32_bf16 v[88:91], v[196:199], v[44:47], 0
    s_nop 1
    v_permlane32_swap_b32 v6, v7
    v_mfma_f32_16x16x32_bf16 v[92:95], v[202:205], v[44:47], 0
    v_add_f32 v6, v6, v7
    v_mov_b32 v7, v6
    v_mfma_f32_16x16x16_bf16 v[80:83], v[188:189], v[48:49], v[80:83]
    s_nop 1
    v_permlane16_swap_b32 v6, v7
    v_mfma_f32_16x16x16_bf16 v[84:87], v[194:195], v[48:49], v[84:87]
    v_add_f32 v6, v6, v7
    v_rcp_f32 v6, v6
    v_mfma_f32_16x16x16_bf16 v[88:91], v[200:201], v[48:49], v[88:91]
    v_mfma_f32_16x16x16_bf16 v[92:95], v[206:207], v[48:49], v[92:95]
    v_mfma_f32_16x16x32_bf16 v[96:99], v[208:211], v[44:47], 0
    v_mfma_f32_16x16x32_bf16 v[100:103], v[214:217], v[44:47], 0
    v_mfma_f32_16x16x32_bf16 v[104:107], v[220:223], v[44:47], 0
    v_mfma_f32_16x16x32_bf16 v[108:111], v[226:229], v[44:47], 0
    s_nop 1
    v_pk_mul_f32 v[80:81], v[80:81], v[6:7] op_sel_hi:[1,0]
    v_pk_mul_f32 v[82:83], v[82:83], v[6:7] op_sel_hi:[1,0]
    v_mfma_f32_16x16x16_bf16 v[96:99], v[212:213], v[48:49], v[96:99]
    v_pk_mul_f32 v[84:85], v[84:85], v[6:7] op_sel_hi:[1,0]
    v_pk_mul_f32 v[86:87], v[86:87], v[6:7] op_sel_hi:[1,0]
    v_mfma_f32_16x16x16_bf16 v[100:103], v[218:219], v[48:49], v[100:103]
    v_cvt_pk_bf16_f32 v56, v80, v81
    v_cvt_pk_bf16_f32 v57, v82, v83
    v_mfma_f32_16x16x16_bf16 v[104:107], v[224:225], v[48:49], v[104:107]
    v_cvt_pk_bf16_f32 v58, v84, v85
    v_cvt_pk_bf16_f32 v59, v86, v87
    v_mfma_f32_16x16x16_bf16 v[108:111], v[230:231], v[48:49], v[108:111]
    buffer_store_dwordx4 v[56:59], v28, s[24:27], 0 offen offset:0 sc1
    v_pk_mul_f32 v[88:89], v[88:89], v[6:7] op_sel_hi:[1,0]
    v_pk_mul_f32 v[90:91], v[90:91], v[6:7] op_sel_hi:[1,0]
    v_pk_mul_f32 v[92:93], v[92:93], v[6:7] op_sel_hi:[1,0]
    v_pk_mul_f32 v[94:95], v[94:95], v[6:7] op_sel_hi:[1,0]
    v_cvt_pk_bf16_f32 v60, v88, v89
    v_cvt_pk_bf16_f32 v61, v90, v91
    v_cvt_pk_bf16_f32 v62, v92, v93
    v_cvt_pk_bf16_f32 v63, v94, v95
    buffer_store_dwordx4 v[60:63], v28, s[24:27], 0 offen offset:1024 sc1
    v_pk_mul_f32 v[96:97], v[96:97], v[6:7] op_sel_hi:[1,0]
    v_pk_mul_f32 v[98:99], v[98:99], v[6:7] op_sel_hi:[1,0]
    v_pk_mul_f32 v[100:101], v[100:101], v[6:7] op_sel_hi:[1,0]
    v_pk_mul_f32 v[102:103], v[102:103], v[6:7] op_sel_hi:[1,0]
    v_cvt_pk_bf16_f32 v64, v96, v97
    v_cvt_pk_bf16_f32 v65, v98, v99
    v_cvt_pk_bf16_f32 v66, v100, v101
    v_cvt_pk_bf16_f32 v67, v102, v103
    buffer_store_dwordx4 v[64:67], v28, s[24:27], 0 offen offset:2048 sc1
    v_pk_mul_f32 v[104:105], v[104:105], v[6:7] op_sel_hi:[1,0]
    v_pk_mul_f32 v[106:107], v[106:107], v[6:7] op_sel_hi:[1,0]
    v_pk_mul_f32 v[108:109], v[108:109], v[6:7] op_sel_hi:[1,0]
    v_pk_mul_f32 v[110:111], v[110:111], v[6:7] op_sel_hi:[1,0]
    v_cvt_pk_bf16_f32 v68, v104, v105
    v_cvt_pk_bf16_f32 v69, v106, v107
    v_cvt_pk_bf16_f32 v70, v108, v109
    v_cvt_pk_bf16_f32 v71, v110, v111
    buffer_store_dwordx4 v[68:71], v28, s[24:27], 0 offen offset:3072 sc1
    s_barrier
    s_waitcnt lgkmcnt(0)
    s_mov_b32 s37, 0
L19:
    s_cmp_lg_u32 s3, 0
    s_cbranch_scc1 L20
    s_cmp_gt_u32 s37, 400000
    s_cbranch_scc1 L20
    buffer_load_dword v29, off, s[52:55], 0 sc1
    s_add_u32 s37, s37, 1
    s_waitcnt vmcnt(0)
    v_readfirstlane_b32 s3, v29
    s_nop 0
    s_branch L19
L20:
    v_mov_b32 v29, s3
    s_mov_b64 exec, 1
    s_waitcnt vmcnt(0)
    buffer_store_dword v29, off, s[24:27], s38 sc1
    s_mov_b64 exec, -1
    s_cmp_ge_u32 s2, 240
    s_cbranch_scc1 L_done
    s_cmp_lt_u32 s30, 4
    s_cbranch_scc1 L_ph2
    s_barrier
    s_barrier
    s_endpgm
L_ph2:
    s_lshr_b32 s33, s2, 3
    s_mul_i32 s6, s33, 52
    s_lshr_b32 s6, s6, 8
    s_mul_i32 s7, s6, 5
    s_sub_u32 s7, s33, s7
    s_and_b32 s51, s2, 7
    s_lshl_b32 s33, s30, 6
    v_xor_b32 v12, s33, v30
    v_xor_b32 v14, 32, v12
    v_add_u32 v13, 0x10000, v12
    v_add_u32 v15, 0x10000, v14
    v_add_u32 v22, 0x20000, v12
    v_add_u32 v23, 0x20000, v14
    v_lshlrev_b32 v16, 4, v1
    v_add_u32 v17, 0x10000, v16
    v_add_u32 v18, 0x20000, v16
    s_add_u32 s40, s51, 1
    s_and_b32 s40, s40, 7
    s_lshl_b32 s40, s40, 15
    s_andn2_b32 s33, s2, 7
    s_lshl_b32 s33, s33, 3
    s_add_u32 s33, s33, s51
    s_lshl_b32 s33, s33, 12
    s_lshl_b32 s34, s30, 10
    s_add_u32 s33, s33, s34
    s_add_u32 s33, s33, 8388608
    v_add_u32 v27, s33, v16
    s_lshl_b32 s33, s2, 15
    s_add_u32 s33, s33, s34
    s_add_u32 s33, s33, 8388608
    v_add_u32 v25, s33, v16
    s_lshl_b32 s33, s2, 2
    s_add_u32 s33, s33, s30
    s_lshl_b32 s33, s33, 10
    s_add_u32 s33, s33, 17825792
    v_min_u32 v26, 6, v1
    v_lshlrev_b32 v26, 7, v26
    v_add_u32 v26, s33, v26
    s_andn2_b32 s33, s2, 7
    s_lshl_b32 s33, s33, 2
    s_add_u32 s33, s33, s30
    s_lshl_b32 s33, s33, 10
    s_add_u32 s33, s33, 17825792
    s_add_u32 s34, s51, 1
    v_add_u32 v4, s34, v1
    v_and_b32 v4, 7, v4
    v_lshlrev_b32 v4, 5, v4
    v_add_u32 v4, v4, v1
    v_lshlrev_b32 v4, 7, v4
    v_add_u32 v4, s33, v4
    v_mov_b32 v5, 0x7ffffff0
    v_cmp_gt_u32 vcc, 6, v1
    s_nop 1
    v_cndmask_b32 v19, v5, v4, vcc
    v_cndmask_b32 v20, v4, v5, vcc
    v_cmp_gt_u32 vcc, 7, v1
    s_nop 1
    v_cndmask_b32 v20, v5, v20, vcc
    s_lshl_b32 s33, s6, 3
    s_add_u32 s33, s33, s51
    s_mul_i32 s33, s33, 20480
    s_lshl_b32 s34, s7, 8
    s_add_u32 s33, s33, s34
    s_lshl_b32 s34, s30, 6
    s_add_u32 s33, s33, s34
    v_mul_u32_u24 v28, 1280, v3
    v_lshl_add_u32 v28, v2, 3, v28
    v_add_u32 v28, s33, v28
    s_barrier
    ds_read_b64_tr_b16 v[32:33], v12 offset:57344
    ds_read_b64_tr_b16 v[34:35], v12 offset:61440
    ds_read_b64_tr_b16 v[36:37], v14 offset:57344
    ds_read_b64_tr_b16 v[38:39], v14 offset:61440
    ds_read_b64_tr_b16 v[40:41], v13 offset:0
    ds_read_b64_tr_b16 v[42:43], v13 offset:4096
    ds_read_b64_tr_b16 v[44:45], v15 offset:0
    ds_read_b64_tr_b16 v[46:47], v15 offset:4096
    ds_read_b64_tr_b16 v[48:49], v13 offset:8192
    ds_read_b64_tr_b16 v[50:51], v13 offset:12288
    ds_read_b64_tr_b16 v[52:53], v15 offset:8192
    ds_read_b64_tr_b16 v[54:55], v15 offset:12288
    ds_read_b64_tr_b16 v[56:57], v13 offset:16384
    ds_read_b64_tr_b16 v[58:59], v13 offset:20480
    ds_read_b64_tr_b16 v[60:61], v15 offset:16384
    ds_read_b64_tr_b16 v[62:63], v15 offset:20480
    ds_read_b64_tr_b16 v[64:65], v12 offset:0
    ds_read_b64_tr_b16 v[66:67], v12 offset:4096
    ds_read_b64_tr_b16 v[68:69], v14 offset:0
    ds_read_b64_tr_b16 v[70:71], v14 offset:4096
    ds_read_b64_tr_b16 v[72:73], v12 offset:8192
    ds_read_b64_tr_b16 v[74:75], v12 offset:12288
    ds_read_b64_tr_b16 v[76:77], v14 offset:8192
    ds_read_b64_tr_b16 v[78:79], v14 offset:12288
    ds_read_b64_tr_b16 v[80:81], v12 offset:16384
    ds_read_b64_tr_b16 v[82:83], v12 offset:20480
    ds_read_b64_tr_b16 v[84:85], v14 offset:16384
    ds_read_b64_tr_b16 v[86:87], v14 offset:20480
    ds_read_b64_tr_b16 v[88:89], v12 offset:24576
    ds_read_b64_tr_b16 v[90:91], v12 offset:28672
    ds_read_b64_tr_b16 v[92:93], v14 offset:24576
    ds_read_b64_tr_b16 v[94:95], v14 offset:28672
    ds_read_b64_tr_b16 v[96:97], v12 offset:32768
    ds_read_b64_tr_b16 v[98:99], v12 offset:36864
    ds_read_b64_tr_b16 v[100:101], v14 offset:32768
    ds_read_b64_tr_b16 v[102:103], v14 offset:36864
    ds_read_b64_tr_b16 v[104:105], v12 offset:40960
    ds_read_b64_tr_b16 v[106:107], v12 offset:45056
    ds_read_b64_tr_b16 v[108:109], v14 offset:40960
    ds_read_b64_tr_b16 v[110:111], v14 offset:45056
    ds_read_b64_tr_b16 v[112:113], v12 offset:49152
    ds_read_b64_tr_b16 v[114:115], v12 offset:53248
    ds_read_b64_tr_b16 v[116:117], v14 offset:49152
    ds_read_b64_tr_b16 v[118:119], v14 offset:53248
    ds_read_b64_tr_b16 v[120:121], v13 offset:49152
    ds_read_b64_tr_b16 v[122:123], v13 offset:53248
    ds_read_b64_tr_b16 v[124:125], v15 offset:49152
    ds_read_b64_tr_b16 v[126:127], v15 offset:53248
    s_waitcnt lgkmcnt(0)
    s_barrier
    s_branch L_pgE
    .p2align 12
L_stubE:
    s_setpc_b64 s[4:5]
L_pgE:
    s_barrier
    ds_read_b128 v[160:163], v16 offset:0
    ds_read_b128 v[164:167], v16 offset:1024
    ds_read_b128 v[168:171], v16 offset:2048
    ds_read_b128 v[172:175], v16 offset:3072
    ds_read_b128 v[176:179], v16 offset:4096
    ds_read_b128 v[180:183], v16 offset:5120
    ds_read_b128 v[184:187], v16 offset:6144
    ds_read_b128 v[188:191], v16 offset:7168
    s_waitcnt lgkmcnt(0)
    v_mfma_f32_16x16x32_bf16 v[224:227], v[32:35], v[160:163], 0
    v_mfma_f32_16x16x32_bf16 v[228:231], v[36:39], v[160:163], 0
    ds_read_b128 v[192:195], v16 offset:8192
    v_mfma_f32_16x16x32_bf16 v[224:227], v[40:43], v[164:167], v[224:227]
    ds_read_b128 v[196:199], v16 offset:9216
    v_mfma_f32_16x16x32_bf16 v[228:231], v[44:47], v[164:167], v[228:231]
    ds_read_b128 v[200:203], v16 offset:10240
    v_mfma_f32_16x16x32_bf16 v[224:227], v[48:51], v[168:171], v[224:227]
    ds_read_b128 v[204:207], v16 offset:11264
    v_mfma_f32_16x16x32_bf16 v[228:231], v[52:55], v[168:171], v[228:231]
    ds_read_b128 v[208:211], v16 offset:12288
    v_mfma_f32_16x16x32_bf16 v[224:227], v[56:59], v[172:175], v[224:227]
    ds_read_b128 v[212:215], v16 offset:13312
    v_mfma_f32_16x16x32_bf16 v[228:231], v[60:63], v[172:175], v[228:231]
    ds_read_b128 v[216:219], v16 offset:14336
    v_mfma_f32_16x16x32_bf16 v[224:227], v[64:67], v[176:179], v[224:227]
    ds_read_b128 v[220:223], v16 offset:15360
    v_mfma_f32_16x16x32_bf16 v[228:231], v[68:71], v[176:179], v[228:231]
    ds_read_b64_tr_b16 v[128:129], v22 offset:0
    ds_read_b64_tr_b16 v[130:131], v22 offset:4096
    ds_read_b64_tr_b16 v[132:133], v23 offset:0
    v_mfma_f32_16x16x32_bf16 v[224:227], v[72:75], v[180:183], v[224:227]
    ds_read_b64_tr_b16 v[134:135], v23 offset:4096
    ds_read_b64_tr_b16 v[136:137], v22 offset:8192
    ds_read_b64_tr_b16 v[138:139], v22 offset:12288
    v_mfma_f32_16x16x32_bf16 v[228:231], v[76:79], v[180:183], v[228:231]
    ds_read_b64_tr_b16 v[140:141], v23 offset:8192
    ds_read_b64_tr_b16 v[142:143], v23 offset:12288
    ds_read_b64_tr_b16 v[144:145], v22 offset:16384
    v_mfma_f32_16x16x32_bf16 v[224:227], v[80:83], v[184:187], v[224:227]
    ds_read_b64_tr_b16 v[146:147], v22 offset:20480
    ds_read_b64_tr_b16 v[148:149], v23 offset:16384
    ds_read_b64_tr_b16 v[150:151], v23 offset:20480
    v_mfma_f32_16x16x32_bf16 v[228:231], v[84:87], v[184:187], v[228:231]
    ds_read_b64_tr_b16 v[152:153], v22 offset:24576
    ds_read_b64_tr_b16 v[154:155], v22 offset:28672
    ds_read_b64_tr_b16 v[156:157], v23 offset:24576
    v_mfma_f32_16x16x32_bf16 v[224:227], v[88:91], v[188:191], v[224:227]
    ds_read_b64_tr_b16 v[158:159], v23 offset:28672
    v_mfma_f32_16x16x32_bf16 v[228:231], v[92:95], v[188:191], v[228:231]
    s_waitcnt lgkmcnt(0)
    v_mfma_f32_16x16x32_bf16 v[224:227], v[96:99], v[192:195], v[224:227]
    v_mfma_f32_16x16x32_bf16 v[228:231], v[100:103], v[192:195], v[228:231]
    s_barrier
    ds_read_b128 v[160:163], v16 offset:16384
    v_mfma_f32_16x16x32_bf16 v[224:227], v[104:107], v[196:199], v[224:227]
    ds_read_b128 v[164:167], v16 offset:17408
    v_mfma_f32_16x16x32_bf16 v[228:231], v[108:111], v[196:199], v[228:231]
    ds_read_b128 v[168:171], v16 offset:18432
    v_mfma_f32_16x16x32_bf16 v[224:227], v[112:115], v[200:203], v[224:227]
    ds_read_b128 v[172:175], v16 offset:19456
    v_mfma_f32_16x16x32_bf16 v[228:231], v[116:119], v[200:203], v[228:231]
    ds_read_b128 v[176:179], v16 offset:20480
    v_mfma_f32_16x16x32_bf16 v[224:227], v[120:123], v[204:207], v[224:227]
    ds_read_b128 v[180:183], v16 offset:21504
    v_mfma_f32_16x16x32_bf16 v[228:231], v[124:127], v[204:207], v[228:231]
    ds_read_b128 v[184:187], v16 offset:22528
    v_mfma_f32_16x16x32_bf16 v[224:227], v[128:131], v[208:211], v[224:227]
    ds_read_b128 v[188:191], v16 offset:23552
    v_mfma_f32_16x16x32_bf16 v[228:231], v[132:135], v[208:211], v[228:231]
    v_mfma_f32_16x16x32_bf16 v[224:227], v[136:139], v[212:215], v[224:227]
    v_mfma_f32_16x16x32_bf16 v[228:231], v[140:143], v[212:215], v[228:231]
    v_mfma_f32_16x16x32_bf16 v[224:227], v[144:147], v[216:219], v[224:227]
    v_mfma_f32_16x16x32_bf16 v[228:231], v[148:151], v[216:219], v[228:231]
    v_mfma_f32_16x16x32_bf16 v[224:227], v[152:155], v[220:223], v[224:227]
    v_mfma_f32_16x16x32_bf16 v[228:231], v[156:159], v[220:223], v[228:231]
    s_waitcnt lgkmcnt(0)
    v_mfma_f32_16x16x32_bf16 v[232:235], v[32:35], v[160:163], 0
    v_mfma_f32_16x16x32_bf16 v[236:239], v[36:39], v[160:163], 0
    ds_read_b128 v[192:195], v16 offset:24576
    v_mfma_f32_16x16x32_bf16 v[232:235], v[40:43], v[164:167], v[232:235]
    ds_read_b128 v[196:199], v16 offset:25600
    v_mfma_f32_16x16x32_bf16 v[236:239], v[44:47], v[164:167], v[236:239]
    ds_read_b128 v[200:203], v16 offset:26624
    v_mfma_f32_16x16x32_bf16 v[232:235], v[48:51], v[168:171], v[232:235]
    ds_read_b128 v[204:207], v16 offset:27648
    v_mfma_f32_16x16x32_bf16 v[236:239], v[52:55], v[168:171], v[236:239]
    ds_read_b128 v[208:211], v16 offset:28672
    v_mfma_f32_16x16x32_bf16 v[232:235], v[56:59], v[172:175], v[232:235]
    ds_read_b128 v[212:215], v16 offset:29696
    v_mfma_f32_16x16x32_bf16 v[236:239], v[60:63], v[172:175], v[236:239]
    ds_read_b128 v[216:219], v16 offset:30720
    v_mfma_f32_16x16x32_bf16 v[232:235], v[64:67], v[176:179], v[232:235]
    ds_read_b128 v[220:223], v16 offset:31744
    v_mfma_f32_16x16x32_bf16 v[236:239], v[68:71], v[176:179], v[236:239]
    v_cvt_pk_bf16_f32 v240, v224, v225
    v_cvt_pk_bf16_f32 v241, v226, v227
    v_mfma_f32_16x16x32_bf16 v[232:235], v[72:75], v[180:183], v[232:235]
    v_cvt_pk_bf16_f32 v242, v228, v229
    v_cvt_pk_bf16_f32 v243, v230, v231
    v_mfma_f32_16x16x32_bf16 v[236:239], v[76:79], v[180:183], v[236:239]
    buffer_store_dwordx4 v[240:243], v27, s[24:27], s40 offen sc1
    s_add_u32 s40, s40, 0x8000
    v_mfma_f32_16x16x32_bf16 v[232:235], v[80:83], v[184:187], v[232:235]
    s_and_b32 s40, s40, 0x3ffff
    v_mfma_f32_16x16x32_bf16 v[236:239], v[84:87], v[184:187], v[236:239]
    v_mfma_f32_16x16x32_bf16 v[232:235], v[88:91], v[188:191], v[232:235]
    v_mfma_f32_16x16x32_bf16 v[236:239], v[92:95], v[188:191], v[236:239]
    s_waitcnt lgkmcnt(0)
    v_mfma_f32_16x16x32_bf16 v[232:235], v[96:99], v[192:195], v[232:235]
    v_mfma_f32_16x16x32_bf16 v[236:239], v[100:103], v[192:195], v[236:239]
    s_barrier
    ds_read_b128 v[160:163], v16 offset:32768
    v_mfma_f32_16x16x32_bf16 v[232:235], v[104:107], v[196:199], v[232:235]
    ds_read_b128 v[164:167], v16 offset:33792
    v_mfma_f32_16x16x32_bf16 v[236:239], v[108:111], v[196:199], v[236:239]
    ds_read_b128 v[168:171], v16 offset:34816
    v_mfma_f32_16x16x32_bf16 v[232:235], v[112:115], v[200:203], v[232:235]
    ds_read_b128 v[172:175], v16 offset:35840
    v_mfma_f32_16x16x32_bf16 v[236:239], v[116:119], v[200:203], v[236:239]
    ds_read_b128 v[176:179], v16 offset:36864
    v_mfma_f32_16x16x32_bf16 v[232:235], v[120:123], v[204:207], v[232:235]
    ds_read_b128 v[180:183], v16 offset:37888
    v_mfma_f32_16x16x32_bf16 v[236:239], v[124:127], v[204:207], v[236:239]
    ds_read_b128 v[184:187], v16 offset:38912
    v_mfma_f32_16x16x32_bf16 v[232:235], v[128:131], v[208:211], v[232:235]
    ds_read_b128 v[188:191], v16 offset:39936
    v_mfma_f32_16x16x32_bf16 v[236:239], v[132:135], v[208:211], v[236:239]
    v_mfma_f32_16x16x32_bf16 v[232:235], v[136:139], v[212:215], v[232:235]
    v_mfma_f32_16x16x32_bf16 v[236:239], v[140:143], v[212:215], v[236:239]
    v_mfma_f32_16x16x32_bf16 v[232:235], v[144:147], v[216:219], v[232:235]
    v_mfma_f32_16x16x32_bf16 v[236:239], v[148:151], v[216:219], v[236:239]
    v_mfma_f32_16x16x32_bf16 v[232:235], v[152:155], v[220:223], v[232:235]
    v_mfma_f32_16x16x32_bf16 v[236:239], v[156:159], v[220:223], v[236:239]
    s_waitcnt lgkmcnt(0)
    v_mfma_f32_16x16x32_bf16 v[224:227], v[32:35], v[160:163], 0
    v_mfma_f32_16x16x32_bf16 v[228:231], v[36:39], v[160:163], 0
    ds_read_b128 v[192:195], v16 offset:40960
    v_mfma_f32_16x16x32_bf16 v[224:227], v[40:43], v[164:167], v[224:227]
    ds_read_b128 v[196:199], v16 offset:41984
    v_mfma_f32_16x16x32_bf16 v[228:231], v[44:47], v[164:167], v[228:231]
    ds_read_b128 v[200:203], v16 offset:43008
    v_mfma_f32_16x16x32_bf16 v[224:227], v[48:51], v[168:171], v[224:227]
    ds_read_b128 v[204:207], v16 offset:44032
    v_mfma_f32_16x16x32_bf16 v[228:231], v[52:55], v[168:171], v[228:231]
    ds_read_b128 v[208:211], v16 offset:45056
    v_mfma_f32_16x16x32_bf16 v[224:227], v[56:59], v[172:175], v[224:227]
    ds_read_b128 v[212:215], v16 offset:46080
    v_mfma_f32_16x16x32_bf16 v[228:231], v[60:63], v[172:175], v[228:231]
    ds_read_b128 v[216:219], v16 offset:47104
    v_mfma_f32_16x16x32_bf16 v[224:227], v[64:67], v[176:179], v[224:227]
    ds_read_b128 v[220:223], v16 offset:48128
    v_mfma_f32_16x16x32_bf16 v[228:231], v[68:71], v[176:179], v[228:231]
    v_cvt_pk_bf16_f32 v244, v232, v233
    v_cvt_pk_bf16_f32 v245, v234, v235
    v_mfma_f32_16x16x32_bf16 v[224:227], v[72:75], v[180:183], v[224:227]
    v_cvt_pk_bf16_f32 v246, v236, v237
    v_cvt_pk_bf16_f32 v247, v238, v239
    v_mfma_f32_16x16x32_bf16 v[228:231], v[76:79], v[180:183], v[228:231]
    buffer_store_dwordx4 v[244:247], v27, s[24:27], s40 offen sc1
    s_add_u32 s40, s40, 0x8000
    v_mfma_f32_16x16x32_bf16 v[224:227], v[80:83], v[184:187], v[224:227]
    s_and_b32 s40, s40, 0x3ffff
    v_mfma_f32_16x16x32_bf16 v[228:231], v[84:87], v[184:187], v[228:231]
    v_mfma_f32_16x16x32_bf16 v[224:227], v[88:91], v[188:191], v[224:227]
    v_mfma_f32_16x16x32_bf16 v[228:231], v[92:95], v[188:191], v[228:231]
    s_waitcnt lgkmcnt(0)
    v_mfma_f32_16x16x32_bf16 v[224:227], v[96:99], v[192:195], v[224:227]
    v_mfma_f32_16x16x32_bf16 v[228:231], v[100:103], v[192:195], v[228:231]
    s_barrier
    ds_read_b128 v[160:163], v16 offset:49152
    v_mfma_f32_16x16x32_bf16 v[224:227], v[104:107], v[196:199], v[224:227]
    ds_read_b128 v[164:167], v16 offset:50176
    v_mfma_f32_16x16x32_bf16 v[228:231], v[108:111], v[196:199], v[228:231]
    ds_read_b128 v[168:171], v16 offset:51200
    v_mfma_f32_16x16x32_bf16 v[224:227], v[112:115], v[200:203], v[224:227]
    ds_read_b128 v[172:175], v16 offset:52224
    v_mfma_f32_16x16x32_bf16 v[228:231], v[116:119], v[200:203], v[228:231]
    ds_read_b128 v[176:179], v16 offset:53248
    v_mfma_f32_16x16x32_bf16 v[224:227], v[120:123], v[204:207], v[224:227]
    ds_read_b128 v[180:183], v16 offset:54272
    v_mfma_f32_16x16x32_bf16 v[228:231], v[124:127], v[204:207], v[228:231]
    ds_read_b128 v[184:187], v16 offset:55296
    v_mfma_f32_16x16x32_bf16 v[224:227], v[128:131], v[208:211], v[224:227]
    ds_read_b128 v[188:191], v16 offset:56320
    v_mfma_f32_16x16x32_bf16 v[228:231], v[132:135], v[208:211], v[228:231]
    v_mfma_f32_16x16x32_bf16 v[224:227], v[136:139], v[212:215], v[224:227]
    v_mfma_f32_16x16x32_bf16 v[228:231], v[140:143], v[212:215], v[228:231]
    v_mfma_f32_16x16x32_bf16 v[224:227], v[144:147], v[216:219], v[224:227]
    v_mfma_f32_16x16x32_bf16 v[228:231], v[148:151], v[216:219], v[228:231]
    v_mfma_f32_16x16x32_bf16 v[224:227], v[152:155], v[220:223], v[224:227]
    v_mfma_f32_16x16x32_bf16 v[228:231], v[156:159], v[220:223], v[228:231]
    s_waitcnt lgkmcnt(0)
    v_mfma_f32_16x16x32_bf16 v[232:235], v[32:35], v[160:163], 0
    v_mfma_f32_16x16x32_bf16 v[236:239], v[36:39], v[160:163], 0
    ds_read_b128 v[192:195], v16 offset:57344
    v_mfma_f32_16x16x32_bf16 v[232:235], v[40:43], v[164:167], v[232:235]
    ds_read_b128 v[196:199], v16 offset:58368
    v_mfma_f32_16x16x32_bf16 v[236:239], v[44:47], v[164:167], v[236:239]
    ds_read_b128 v[200:203], v16 offset:59392
    v_mfma_f32_16x16x32_bf16 v[232:235], v[48:51], v[168:171], v[232:235]
    ds_read_b128 v[204:207], v16 offset:60416
    v_mfma_f32_16x16x32_bf16 v[236:239], v[52:55], v[168:171], v[236:239]
    ds_read_b128 v[208:211], v16 offset:61440
    v_mfma_f32_16x16x32_bf16 v[232:235], v[56:59], v[172:175], v[232:235]
    ds_read_b128 v[212:215], v16 offset:62464
    v_mfma_f32_16x16x32_bf16 v[236:239], v[60:63], v[172:175], v[236:239]
    ds_read_b128 v[216:219], v16 offset:63488
    v_mfma_f32_16x16x32_bf16 v[232:235], v[64:67], v[176:179], v[232:235]
    ds_read_b128 v[220:223], v16 offset:64512
    v_mfma_f32_16x16x32_bf16 v[236:239], v[68:71], v[176:179], v[236:239]
    v_cvt_pk_bf16_f32 v248, v224, v225
    v_cvt_pk_bf16_f32 v249, v226, v227
    v_mfma_f32_16x16x32_bf16 v[232:235], v[72:75], v[180:183], v[232:235]
    v_cvt_pk_bf16_f32 v250, v228, v229
    v_cvt_pk_bf16_f32 v251, v230, v231
    v_mfma_f32_16x16x32_bf16 v[236:239], v[76:79], v[180:183], v[236:239]
    buffer_store_dwordx4 v[248:251], v27, s[24:27], s40 offen sc1
    s_add_u32 s40, s40, 0x8000
    v_mfma_f32_16x16x32_bf16 v[232:235], v[80:83], v[184:187], v[232:235]
    s_and_b32 s40, s40, 0x3ffff
    v_mfma_f32_16x16x32_bf16 v[236:239], v[84:87], v[184:187], v[236:239]
    v_mfma_f32_16x16x32_bf16 v[232:235], v[88:91], v[188:191], v[232:235]
    v_mfma_f32_16x16x32_bf16 v[236:239], v[92:95], v[188:191], v[236:239]
    s_waitcnt lgkmcnt(0)
    v_mfma_f32_16x16x32_bf16 v[232:235], v[96:99], v[192:195], v[232:235]
    v_mfma_f32_16x16x32_bf16 v[236:239], v[100:103], v[192:195], v[236:239]
    s_barrier
    ds_read_b128 v[160:163], v17 offset:0
    v_mfma_f32_16x16x32_bf16 v[232:235], v[104:107], v[196:199], v[232:235]
    ds_read_b128 v[164:167], v17 offset:1024
    v_mfma_f32_16x16x32_bf16 v[236:239], v[108:111], v[196:199], v[236:239]
    ds_read_b128 v[168:171], v17 offset:2048
    v_mfma_f32_16x16x32_bf16 v[232:235], v[112:115], v[200:203], v[232:235]
    ds_read_b128 v[172:175], v17 offset:3072
    v_mfma_f32_16x16x32_bf16 v[236:239], v[116:119], v[200:203], v[236:239]
    ds_read_b128 v[176:179], v17 offset:4096
    v_mfma_f32_16x16x32_bf16 v[232:235], v[120:123], v[204:207], v[232:235]
    ds_read_b128 v[180:183], v17 offset:5120
    v_mfma_f32_16x16x32_bf16 v[236:239], v[124:127], v[204:207], v[236:239]
    ds_read_b128 v[184:187], v17 offset:6144
    v_mfma_f32_16x16x32_bf16 v[232:235], v[128:131], v[208:211], v[232:235]
    ds_read_b128 v[188:191], v17 offset:7168
    v_mfma_f32_16x16x32_bf16 v[236:239], v[132:135], v[208:211], v[236:239]
    v_mfma_f32_16x16x32_bf16 v[232:235], v[136:139], v[212:215], v[232:235]
    v_mfma_f32_16x16x32_bf16 v[236:239], v[140:143], v[212:215], v[236:239]
    v_mfma_f32_16x16x32_bf16 v[232:235], v[144:147], v[216:219], v[232:235]
    v_mfma_f32_16x16x32_bf16 v[236:239], v[148:151], v[216:219], v[236:239]
    v_mfma_f32_16x16x32_bf16 v[232:235], v[152:155], v[220:223], v[232:235]
    v_mfma_f32_16x16x32_bf16 v[236:239], v[156:159], v[220:223], v[236:239]
    s_waitcnt lgkmcnt(0)
    v_mfma_f32_16x16x32_bf16 v[224:227], v[32:35], v[160:163], 0
    v_mfma_f32_16x16x32_bf16 v[228:231], v[36:39], v[160:163], 0
    ds_read_b128 v[192:195], v17 offset:8192
    v_mfma_f32_16x16x32_bf16 v[224:227], v[40:43], v[164:167], v[224:227]
    ds_read_b128 v[196:199], v17 offset:9216
    v_mfma_f32_16x16x32_bf16 v[228:231], v[44:47], v[164:167], v[228:231]
    ds_read_b128 v[200:203], v17 offset:10240
    v_mfma_f32_16x16x32_bf16 v[224:227], v[48:51], v[168:171], v[224:227]
    ds_read_b128 v[204:207], v17 offset:11264
    v_mfma_f32_16x16x32_bf16 v[228:231], v[52:55], v[168:171], v[228:231]
    ds_read_b128 v[208:211], v17 offset:12288
    v_mfma_f32_16x16x32_bf16 v[224:227], v[56:59], v[172:175], v[224:227]
    ds_read_b128 v[212:215], v17 offset:13312
    v_mfma_f32_16x16x32_bf16 v[228:231], v[60:63], v[172:175], v[228:231]
    ds_read_b128 v[216:219], v17 offset:14336
    v_mfma_f32_16x16x32_bf16 v[224:227], v[64:67], v[176:179], v[224:227]
    ds_read_b128 v[220:223], v17 offset:15360
    v_mfma_f32_16x16x32_bf16 v[228:231], v[68:71], v[176:179], v[228:231]
    v_cvt_pk_bf16_f32 v252, v232, v233
    v_cvt_pk_bf16_f32 v253, v234, v235
    v_mfma_f32_16x16x32_bf16 v[224:227], v[72:75], v[180:183], v[224:227]
    v_cvt_pk_bf16_f32 v254, v236, v237
    v_cvt_pk_bf16_f32 v255, v238, v239
    v_mfma_f32_16x16x32_bf16 v[228:231], v[76:79], v[180:183], v[228:231]
    buffer_store_dwordx4 v[252:255], v27, s[24:27], s40 offen sc1
    s_add_u32 s40, s40, 0x8000
    v_mfma_f32_16x16x32_bf16 v[224:227], v[80:83], v[184:187], v[224:227]
    s_and_b32 s40, s40, 0x3ffff
    v_mfma_f32_16x16x32_bf16 v[228:231], v[84:87], v[184:187], v[228:231]
    v_mfma_f32_16x16x32_bf16 v[224:227], v[88:91], v[188:191], v[224:227]
    v_mfma_f32_16x16x32_bf16 v[228:231], v[92:95], v[188:191], v[228:231]
    s_waitcnt lgkmcnt(0)
    v_mfma_f32_16x16x32_bf16 v[224:227], v[96:99], v[192:195], v[224:227]
    v_mfma_f32_16x16x32_bf16 v[228:231], v[100:103], v[192:195], v[228:231]
    s_barrier
    ds_read_b128 v[160:163], v17 offset:16384
    v_mfma_f32_16x16x32_bf16 v[224:227], v[104:107], v[196:199], v[224:227]
    ds_read_b128 v[164:167], v17 offset:17408
    v_mfma_f32_16x16x32_bf16 v[228:231], v[108:111], v[196:199], v[228:231]
    ds_read_b128 v[168:171], v17 offset:18432
    v_mfma_f32_16x16x32_bf16 v[224:227], v[112:115], v[200:203], v[224:227]
    ds_read_b128 v[172:175], v17 offset:19456
    v_mfma_f32_16x16x32_bf16 v[228:231], v[116:119], v[200:203], v[228:231]
    ds_read_b128 v[176:179], v17 offset:20480
    v_mfma_f32_16x16x32_bf16 v[224:227], v[120:123], v[204:207], v[224:227]
    ds_read_b128 v[180:183], v17 offset:21504
    v_mfma_f32_16x16x32_bf16 v[228:231], v[124:127], v[204:207], v[228:231]
    ds_read_b128 v[184:187], v17 offset:22528
    v_mfma_f32_16x16x32_bf16 v[224:227], v[128:131], v[208:211], v[224:227]
    ds_read_b128 v[188:191], v17 offset:23552
    v_mfma_f32_16x16x32_bf16 v[228:231], v[132:135], v[208:211], v[228:231]
    v_mfma_f32_16x16x32_bf16 v[224:227], v[136:139], v[212:215], v[224:227]
    v_mfma_f32_16x16x32_bf16 v[228:231], v[140:143], v[212:215], v[228:231]
    v_mfma_f32_16x16x32_bf16 v[224:227], v[144:147], v[216:219], v[224:227]
    v_mfma_f32_16x16x32_bf16 v[228:231], v[148:151], v[216:219], v[228:231]
    v_mfma_f32_16x16x32_bf16 v[224:227], v[152:155], v[220:223], v[224:227]
    v_mfma_f32_16x16x32_bf16 v[228:231], v[156:159], v[220:223], v[228:231]
    s_waitcnt lgkmcnt(0)
    v_mfma_f32_16x16x32_bf16 v[232:235], v[32:35], v[160:163], 0
    v_mfma_f32_16x16x32_bf16 v[236:239], v[36:39], v[160:163], 0
    ds_read_b128 v[192:195], v17 offset:24576
    v_mfma_f32_16x16x32_bf16 v[232:235], v[40:43], v[164:167], v[232:235]
    ds_read_b128 v[196:199], v17 offset:25600
    v_mfma_f32_16x16x32_bf16 v[236:239], v[44:47], v[164:167], v[236:239]
    ds_read_b128 v[200:203], v17 offset:26624
    v_mfma_f32_16x16x32_bf16 v[232:235], v[48:51], v[168:171], v[232:235]
    ds_read_b128 v[204:207], v17 offset:27648
    v_mfma_f32_16x16x32_bf16 v[236:239], v[52:55], v[168:171], v[236:239]
    ds_read_b128 v[208:211], v17 offset:28672
    v_mfma_f32_16x16x32_bf16 v[232:235], v[56:59], v[172:175], v[232:235]
    ds_read_b128 v[212:215], v17 offset:29696
    v_mfma_f32_16x16x32_bf16 v[236:239], v[60:63], v[172:175], v[236:239]
    ds_read_b128 v[216:219], v17 offset:30720
    v_mfma_f32_16x16x32_bf16 v[232:235], v[64:67], v[176:179], v[232:235]
    ds_read_b128 v[220:223], v17 offset:31744
    v_mfma_f32_16x16x32_bf16 v[236:239], v[68:71], v[176:179], v[236:239]
    v_cvt_pk_bf16_f32 v240, v224, v225
    v_cvt_pk_bf16_f32 v241, v226, v227
    v_mfma_f32_16x16x32_bf16 v[232:235], v[72:75], v[180:183], v[232:235]
    v_cvt_pk_bf16_f32 v242, v228, v229
    v_cvt_pk_bf16_f32 v243, v230, v231
    v_mfma_f32_16x16x32_bf16 v[236:239], v[76:79], v[180:183], v[236:239]
    buffer_store_dwordx4 v[240:243], v27, s[24:27], s40 offen sc1
    s_add_u32 s40, s40, 0x8000
    v_mfma_f32_16x16x32_bf16 v[232:235], v[80:83], v[184:187], v[232:235]
    s_and_b32 s40, s40, 0x3ffff
    v_mfma_f32_16x16x32_bf16 v[236:239], v[84:87], v[184:187], v[236:239]
    v_mfma_f32_16x16x32_bf16 v[232:235], v[88:91], v[188:191], v[232:235]
    v_mfma_f32_16x16x32_bf16 v[236:239], v[92:95], v[188:191], v[236:239]
    s_waitcnt lgkmcnt(0)
    v_mfma_f32_16x16x32_bf16 v[232:235], v[96:99], v[192:195], v[232:235]
    v_mfma_f32_16x16x32_bf16 v[236:239], v[100:103], v[192:195], v[236:239]
    s_barrier
    ds_read_b128 v[160:163], v17 offset:32768
    v_mfma_f32_16x16x32_bf16 v[232:235], v[104:107], v[196:199], v[232:235]
    ds_read_b128 v[164:167], v17 offset:33792
    v_mfma_f32_16x16x32_bf16 v[236:239], v[108:111], v[196:199], v[236:239]
    ds_read_b128 v[168:171], v17 offset:34816
    v_mfma_f32_16x16x32_bf16 v[232:235], v[112:115], v[200:203], v[232:235]
    ds_read_b128 v[172:175], v17 offset:35840
    v_mfma_f32_16x16x32_bf16 v[236:239], v[116:119], v[200:203], v[236:239]
    ds_read_b128 v[176:179], v17 offset:36864
    v_mfma_f32_16x16x32_bf16 v[232:235], v[120:123], v[204:207], v[232:235]
    ds_read_b128 v[180:183], v17 offset:37888
    v_mfma_f32_16x16x32_bf16 v[236:239], v[124:127], v[204:207], v[236:239]
    ds_read_b128 v[184:187], v17 offset:38912
    v_mfma_f32_16x16x32_bf16 v[232:235], v[128:131], v[208:211], v[232:235]
    ds_read_b128 v[188:191], v17 offset:39936
    v_mfma_f32_16x16x32_bf16 v[236:239], v[132:135], v[208:211], v[236:239]
    v_mfma_f32_16x16x32_bf16 v[232:235], v[136:139], v[212:215], v[232:235]
    v_mfma_f32_16x16x32_bf16 v[236:239], v[140:143], v[212:215], v[236:239]
    v_mfma_f32_16x16x32_bf16 v[232:235], v[144:147], v[216:219], v[232:235]
    v_mfma_f32_16x16x32_bf16 v[236:239], v[148:151], v[216:219], v[236:239]
    v_mfma_f32_16x16x32_bf16 v[232:235], v[152:155], v[220:223], v[232:235]
    v_mfma_f32_16x16x32_bf16 v[236:239], v[156:159], v[220:223], v[236:239]
    s_waitcnt lgkmcnt(0)
    v_mfma_f32_16x16x32_bf16 v[224:227], v[32:35], v[160:163], 0
    v_mfma_f32_16x16x32_bf16 v[228:231], v[36:39], v[160:163], 0
    ds_read_b128 v[192:195], v17 offset:40960
    v_mfma_f32_16x16x32_bf16 v[224:227], v[40:43], v[164:167], v[224:227]
    ds_read_b128 v[196:199], v17 offset:41984
    v_mfma_f32_16x16x32_bf16 v[228:231], v[44:47], v[164:167], v[228:231]
    ds_read_b128 v[200:203], v17 offset:43008
    v_mfma_f32_16x16x32_bf16 v[224:227], v[48:51], v[168:171], v[224:227]
    ds_read_b128 v[204:207], v17 offset:44032
    v_mfma_f32_16x16x32_bf16 v[228:231], v[52:55], v[168:171], v[228:231]
    ds_read_b128 v[208:211], v17 offset:45056
    v_mfma_f32_16x16x32_bf16 v[224:227], v[56:59], v[172:175], v[224:227]
    ds_read_b128 v[212:215], v17 offset:46080
    v_mfma_f32_16x16x32_bf16 v[228:231], v[60:63], v[172:175], v[228:231]
    ds_read_b128 v[216:219], v17 offset:47104
    v_mfma_f32_16x16x32_bf16 v[224:227], v[64:67], v[176:179], v[224:227]
    ds_read_b128 v[220:223], v17 offset:48128
    v_mfma_f32_16x16x32_bf16 v[228:231], v[68:71], v[176:179], v[228:231]
    v_cvt_pk_bf16_f32 v244, v232, v233
    v_cvt_pk_bf16_f32 v245, v234, v235
    v_mfma_f32_16x16x32_bf16 v[224:227], v[72:75], v[180:183], v[224:227]
    v_cvt_pk_bf16_f32 v246, v236, v237
    v_cvt_pk_bf16_f32 v247, v238, v239
    v_mfma_f32_16x16x32_bf16 v[228:231], v[76:79], v[180:183], v[228:231]
    buffer_store_dwordx4 v[244:247], v27, s[24:27], s40 offen sc1
    s_add_u32 s40, s40, 0x8000
    v_mfma_f32_16x16x32_bf16 v[224:227], v[80:83], v[184:187], v[224:227]
    s_and_b32 s40, s40, 0x3ffff
    v_mfma_f32_16x16x32_bf16 v[228:231], v[84:87], v[184:187], v[228:231]
    v_mfma_f32_16x16x32_bf16 v[224:227], v[88:91], v[188:191], v[224:227]
    v_mfma_f32_16x16x32_bf16 v[228:231], v[92:95], v[188:191], v[228:231]
    s_waitcnt lgkmcnt(0)
    v_mfma_f32_16x16x32_bf16 v[224:227], v[96:99], v[192:195], v[224:227]
    v_mfma_f32_16x16x32_bf16 v[228:231], v[100:103], v[192:195], v[228:231]
    s_barrier
    ds_read_b128 v[160:163], v17 offset:49152
    v_mfma_f32_16x16x32_bf16 v[224:227], v[104:107], v[196:199], v[224:227]
    ds_read_b128 v[164:167], v17 offset:50176
    v_mfma_f32_16x16x32_bf16 v[228:231], v[108:111], v[196:199], v[228:231]
    ds_read_b128 v[168:171], v17 offset:51200
    v_mfma_f32_16x16x32_bf16 v[224:227], v[112:115], v[200:203], v[224:227]
    ds_read_b128 v[172:175], v17 offset:52224
    v_mfma_f32_16x16x32_bf16 v[228:231], v[116:119], v[200:203], v[228:231]
    ds_read_b128 v[176:179], v17 offset:53248
    v_mfma_f32_16x16x32_bf16 v[224:227], v[120:123], v[204:207], v[224:227]
    ds_read_b128 v[180:183], v17 offset:54272
    v_mfma_f32_16x16x32_bf16 v[228:231], v[124:127], v[204:207], v[228:231]
    ds_read_b128 v[184:187], v17 offset:55296
    v_mfma_f32_16x16x32_bf16 v[224:227], v[128:131], v[208:211], v[224:227]
    ds_read_b128 v[188:191], v17 offset:56320
    v_mfma_f32_16x16x32_bf16 v[228:231], v[132:135], v[208:211], v[228:231]
    v_mfma_f32_16x16x32_bf16 v[224:227], v[136:139], v[212:215], v[224:227]
    v_mfma_f32_16x16x32_bf16 v[228:231], v[140:143], v[212:215], v[228:231]
    v_mfma_f32_16x16x32_bf16 v[224:227], v[144:147], v[216:219], v[224:227]
    v_mfma_f32_16x16x32_bf16 v[228:231], v[148:151], v[216:219], v[228:231]
    v_mfma_f32_16x16x32_bf16 v[224:227], v[152:155], v[220:223], v[224:227]
    v_mfma_f32_16x16x32_bf16 v[228:231], v[156:159], v[220:223], v[228:231]
    s_waitcnt lgkmcnt(0)
    v_mfma_f32_16x16x32_bf16 v[232:235], v[32:35], v[160:163], 0
    v_mfma_f32_16x16x32_bf16 v[236:239], v[36:39], v[160:163], 0
    ds_read_b128 v[192:195], v17 offset:57344
    v_mfma_f32_16x16x32_bf16 v[232:235], v[40:43], v[164:167], v[232:235]
    ds_read_b128 v[196:199], v17 offset:58368
    v_mfma_f32_16x16x32_bf16 v[236:239], v[44:47], v[164:167], v[236:239]
    ds_read_b128 v[200:203], v17 offset:59392
    v_mfma_f32_16x16x32_bf16 v[232:235], v[48:51], v[168:171], v[232:235]
    ds_read_b128 v[204:207], v17 offset:60416
    v_mfma_f32_16x16x32_bf16 v[236:239], v[52:55], v[168:171], v[236:239]
    ds_read_b128 v[208:211], v17 offset:61440
    v_mfma_f32_16x16x32_bf16 v[232:235], v[56:59], v[172:175], v[232:235]
    ds_read_b128 v[212:215], v17 offset:62464
    v_mfma_f32_16x16x32_bf16 v[236:239], v[60:63], v[172:175], v[236:239]
    ds_read_b128 v[216:219], v17 offset:63488
    v_mfma_f32_16x16x32_bf16 v[232:235], v[64:67], v[176:179], v[232:235]
    ds_read_b128 v[220:223], v17 offset:64512
    v_mfma_f32_16x16x32_bf16 v[236:239], v[68:71], v[176:179], v[236:239]
    v_cvt_pk_bf16_f32 v248, v224, v225
    v_cvt_pk_bf16_f32 v249, v226, v227
    v_mfma_f32_16x16x32_bf16 v[232:235], v[72:75], v[180:183], v[232:235]
    v_cvt_pk_bf16_f32 v250, v228, v229
    v_cvt_pk_bf16_f32 v251, v230, v231
    v_mfma_f32_16x16x32_bf16 v[236:239], v[76:79], v[180:183], v[236:239]
    buffer_store_dwordx4 v[248:251], v27, s[24:27], s40 offen sc1
    s_add_u32 s40, s40, 0x8000
    v_mfma_f32_16x16x32_bf16 v[232:235], v[80:83], v[184:187], v[232:235]
    s_and_b32 s40, s40, 0x3ffff
    v_mfma_f32_16x16x32_bf16 v[236:239], v[84:87], v[184:187], v[236:239]
    v_mfma_f32_16x16x32_bf16 v[232:235], v[88:91], v[188:191], v[232:235]
    v_mfma_f32_16x16x32_bf16 v[236:239], v[92:95], v[188:191], v[236:239]
    s_waitcnt lgkmcnt(0)
    v_mfma_f32_16x16x32_bf16 v[232:235], v[96:99], v[192:195], v[232:235]
    v_mfma_f32_16x16x32_bf16 v[236:239], v[100:103], v[192:195], v[236:239]
    s_waitcnt vmcnt(1)
    buffer_store_dword v29, v19, s[24:27], 0 offen sc1
    v_mfma_f32_16x16x32_bf16 v[232:235], v[104:107], v[196:199], v[232:235]
    v_mfma_f32_16x16x32_bf16 v[236:239], v[108:111], v[196:199], v[236:239]
    v_mfma_f32_16x16x32_bf16 v[232:235], v[112:115], v[200:203], v[232:235]
    v_mfma_f32_16x16x32_bf16 v[236:239], v[116:119], v[200:203], v[236:239]
    v_mfma_f32_16x16x32_bf16 v[232:235], v[120:123], v[204:207], v[232:235]
    v_mfma_f32_16x16x32_bf16 v[236:239], v[124:127], v[204:207], v[236:239]
    v_mfma_f32_16x16x32_bf16 v[232:235], v[128:131], v[208:211], v[232:235]
    v_mfma_f32_16x16x32_bf16 v[236:239], v[132:135], v[208:211], v[236:239]
    v_mfma_f32_16x16x32_bf16 v[232:235], v[136:139], v[212:215], v[232:235]
    v_mfma_f32_16x16x32_bf16 v[236:239], v[140:143], v[212:215], v[236:239]
    v_mfma_f32_16x16x32_bf16 v[232:235], v[144:147], v[216:219], v[232:235]
    v_mfma_f32_16x16x32_bf16 v[236:239], v[148:151], v[216:219], v[236:239]
    v_mfma_f32_16x16x32_bf16 v[232:235], v[152:155], v[220:223], v[232:235]
    v_mfma_f32_16x16x32_bf16 v[236:239], v[156:159], v[220:223], v[236:239]
    s_waitcnt lgkmcnt(0)
    s_waitcnt vmcnt(1)
    buffer_store_dword v29, v20, s[24:27], 0 offen sc1
    s_mov_b32 s41, 0x7f
    s_mov_b32 s37, 0
    s_mov_b32 s42, 0xffff0000
    buffer_load_dword v4, v26, s[24:27], 0 offen sc1
    s_branch L_poll2w
    .p2align 12
L_stubF:
    s_setpc_b64 s[4:5]
L_pgF:
L_poll2:
    buffer_load_dword v4, v26, s[24:27], 0 offen sc1
L_poll2w:
    s_add_u32 s37, s37, 1
    s_waitcnt vmcnt(0)
L_poll2x:
    v_cmp_eq_u32 vcc, s3, v4
    s_nop 1
    s_and_b32 s35, vcc_lo, s41
    s_andn2_b32 s41, s41, s35
    s_bitcmp1_b32 s35, 0
    s_cbranch_scc0 L21
    s_add_u32 s33, s51, 7
    s_and_b32 s33, s33, 7
    s_lshl_b32 s33, s33, 12
    buffer_load_dwordx4 v[32:35], v25, s[24:27], s33 offen sc1
L21:
    s_bitcmp1_b32 s35, 1
    s_cbranch_scc0 L22
    s_add_u32 s33, s51, 6
    s_and_b32 s33, s33, 7
    s_lshl_b32 s33, s33, 12
    buffer_load_dwordx4 v[36:39], v25, s[24:27], s33 offen sc1
L22:
    s_bitcmp1_b32 s35, 2
    s_cbranch_scc0 L23
    s_add_u32 s33, s51, 5
    s_and_b32 s33, s33, 7
    s_lshl_b32 s33, s33, 12
    buffer_load_dwordx4 v[40:43], v25, s[24:27], s33 offen sc1
L23:
    s_bitcmp1_b32 s35, 3
    s_cbranch_scc0 L24
    s_add_u32 s33, s51, 4
    s_and_b32 s33, s33, 7
    s_lshl_b32 s33, s33, 12
    buffer_load_dwordx4 v[44:47], v25, s[24:27], s33 offen sc1
L24:
    s_bitcmp1_b32 s35, 4
    s_cbranch_scc0 L25
    s_add_u32 s33, s51, 3
    s_and_b32 s33, s33, 7
    s_lshl_b32 s33, s33, 12
    buffer_load_dwordx4 v[48:51], v25, s[24:27], s33 offen sc1
L25:
    s_bitcmp1_b32 s35, 5
    s_cbranch_scc0 L26
    s_add_u32 s33, s51, 2
    s_and_b32 s33, s33, 7
    s_lshl_b32 s33, s33, 12
    buffer_load_dwordx4 v[52:55], v25, s[24:27], s33 offen sc1
L26:
    s_bitcmp1_b32 s35, 6
    s_cbranch_scc0 L27
    s_add_u32 s33, s51, 1
    s_and_b32 s33, s33, 7
    s_lshl_b32 s33, s33, 12
    buffer_load_dwordx4 v[56:59], v25, s[24:27], s33 offen sc1
L27:
    s_cmp_gt_u32 s37, 400000
    s_cbranch_scc1 L_p2go
    s_cmp_lg_u32 s41, 0
    s_cbranch_scc1 L_poll2
L_p2go:
    s_waitcnt vmcnt(0)
    v_lshlrev_b32 v4, 16, v32
    v_and_b32 v5, s42, v32
    v_pk_add_f32 v[232:233], v[232:233], v[4:5]
    v_lshlrev_b32 v6, 16, v33
    v_and_b32 v7, s42, v33
    v_pk_add_f32 v[234:235], v[234:235], v[6:7]
    v_lshlrev_b32 v4, 16, v34
    v_and_b32 v5, s42, v34
    v_pk_add_f32 v[236:237], v[236:237], v[4:5]
    v_lshlrev_b32 v6, 16, v35
    v_and_b32 v7, s42, v35
    v_pk_add_f32 v[238:239], v[238:239], v[6:7]
    v_lshlrev_b32 v4, 16, v36
    v_and_b32 v5, s42, v36
    v_pk_add_f32 v[232:233], v[232:233], v[4:5]
    v_lshlrev_b32 v6, 16, v37
    v_and_b32 v7, s42, v37
    v_pk_add_f32 v[234:235], v[234:235], v[6:7]
    v_lshlrev_b32 v4, 16, v38
    v_and_b32 v5, s42, v38
    v_pk_add_f32 v[236:237], v[236:237], v[4:5]
    v_lshlrev_b32 v6, 16, v39
    v_and_b32 v7, s42, v39
    v_pk_add_f32 v[238:239], v[238:239], v[6:7]
    v_lshlrev_b32 v4, 16, v40
    v_and_b32 v5, s42, v40
    v_pk_add_f32 v[232:233], v[232:233], v[4:5]
    v_lshlrev_b32 v6, 16, v41
    v_and_b32 v7, s42, v41
    v_pk_add_f32 v[234:235], v[234:235], v[6:7]
    v_lshlrev_b32 v4, 16, v42
    v_and_b32 v5, s42, v42
    v_pk_add_f32 v[236:237], v[236:237], v[4:5]
    v_lshlrev_b32 v6, 16, v43
    v_and_b32 v7, s42, v43
    v_pk_add_f32 v[238:239], v[238:239], v[6:7]
    v_lshlrev_b32 v4, 16, v44
    v_and_b32 v5, s42, v44
    v_pk_add_f32 v[232:233], v[232:233], v[4:5]
    v_lshlrev_b32 v6, 16, v45
    v_and_b32 v7, s42, v45
    v_pk_add_f32 v[234:235], v[234:235], v[6:7]
    v_lshlrev_b32 v4, 16, v46
    v_and_b32 v5, s42, v46
    v_pk_add_f32 v[236:237], v[236:237], v[4:5]
    v_lshlrev_b32 v6, 16, v47
    v_and_b32 v7, s42, v47
    v_pk_add_f32 v[238:239], v[238:239], v[6:7]
    v_lshlrev_b32 v4, 16, v48
    v_and_b32 v5, s42, v48
    v_pk_add_f32 v[232:233], v[232:233], v[4:5]
    v_lshlrev_b32 v6, 16, v49
    v_and_b32 v7, s42, v49
    v_pk_add_f32 v[234:235], v[234:235], v[6:7]
    v_lshlrev_b32 v4, 16, v50
    v_and_b32 v5, s42, v50
    v_pk_add_f32 v[236:237], v[236:237], v[4:5]
    v_lshlrev_b32 v6, 16, v51
    v_and_b32 v7, s42, v51
    v_pk_add_f32 v[238:239], v[238:239], v[6:7]
    v_lshlrev_b32 v4, 16, v52
    v_and_b32 v5, s42, v52
    v_pk_add_f32 v[232:233], v[232:233], v[4:5]
    v_lshlrev_b32 v6, 16, v53
    v_and_b32 v7, s42, v53
    v_pk_add_f32 v[234:235], v[234:235], v[6:7]
    v_lshlrev_b32 v4, 16, v54
    v_and_b32 v5, s42, v54
    v_pk_add_f32 v[236:237], v[236:237], v[4:5]
    v_lshlrev_b32 v6, 16, v55
    v_and_b32 v7, s42, v55
    v_pk_add_f32 v[238:239], v[238:239], v[6:7]
    v_lshlrev_b32 v4, 16, v56
    v_and_b32 v5, s42, v56
    v_pk_add_f32 v[232:233], v[232:233], v[4:5]
    v_lshlrev_b32 v6, 16, v57
    v_and_b32 v7, s42, v57
    v_pk_add_f32 v[234:235], v[234:235], v[6:7]
    v_lshlrev_b32 v4, 16, v58
    v_and_b32 v5, s42, v58
    v_pk_add_f32 v[236:237], v[236:237], v[4:5]
    v_lshlrev_b32 v6, 16, v59
    v_and_b32 v7, s42, v59
    v_pk_add_f32 v[238:239], v[238:239], v[6:7]
    v_cvt_pk_bf16_f32 v32, v232, v233
    v_cvt_pk_bf16_f32 v33, v234, v235
    v_cvt_pk_bf16_f32 v34, v236, v237
    v_cvt_pk_bf16_f32 v35, v238, v239
    buffer_store_dwordx2 v[32:33], v28, s[56:59], 0 offen
    buffer_store_dwordx2 v[34:35], v28, s[56:59], 0 offen offset:32
L_done:
L_end:
    s_endpgm
L_codeend:
.section .rodata,"a"
.p2align 6
.amdhsa_kernel standalone__mha_block_cached__near_ridge_kernel
  .amdhsa_next_free_vgpr 256
  .amdhsa_next_free_sgpr 64
  .amdhsa_accum_offset 256
  .amdhsa_group_segment_fixed_size 0
  .amdhsa_kernarg_size 64
  .amdhsa_user_sgpr_count 2
  .amdhsa_user_sgpr_kernarg_segment_ptr 1
  .amdhsa_system_sgpr_workgroup_id_x 1
.end_amdhsa_kernel
```
